```python
import torch

def _softmax(x, axis=-1):
    return torch.softmax(x, dim=axis)

def _gelu(x):
    return torch.nn.functional.gelu(x, approximate='tanh')

def _silu(x):
    return torch.nn.functional.silu(x)

def _sigmoid(x):
    return torch.sigmoid(x)

def _layernorm(x, axis=-1, eps=1e-05):
    m = x.mean(dim=axis, keepdim=True)
    v = x.var(dim=axis, keepdim=True, unbiased=False)
    return (x - m) / torch.sqrt(v + eps)

def _scatter_add(tgt, idx, src, axis=0):
    return tgt.clone().index_add_(axis, idx, src)

def _segment_sum(src, seg, n):
    out = torch.zeros((n,) + src.shape[1:], dtype=src.dtype)
    return out.index_add_(0, seg, src)

def _pad(x, pw):
    flat = tuple((v for pair in reversed(pw) for v in pair))
    return torch.nn.functional.pad(x, flat)
kernel_name = 'standalone__autoregressive_conv_wavenet__speech'

def setup_inputs():

    _w = lambda a: (lambda t: t.to(torch.bfloat16) if t.is_floating_point() else t)(torch.as_tensor(a))
    B, T, D, K = (2, 16000, 144, 15)
    return {'x': _w((lambda *s: torch.randn(*s, dtype=torch.bfloat16) * 0.1)(B, T, D)), 'w': _w((lambda *s: torch.randn(*s, dtype=torch.bfloat16) * 0.1)(K, D, 2 * D)), 'w_o': _w((lambda *s: torch.randn(*s, dtype=torch.bfloat16) * 0.05)(D, D))}

def reference(x, w, w_o):
    B, T, D = x.shape
    K = w.shape[0]
    dil = 2
    pad = (K - 1) * dil
    xp = _pad(x, ((0, 0), (pad, 0), (0, 0)))
    h = torch.einsum('btc,cd->btd', xp[:, pad:pad + T, :], w[0])
    for i in range(1, K):
        off = pad - i * dil
        h = h + torch.einsum('btc,cd->btd', xp[:, off:off + T, :], w[i])
    f = h[..., :D].clone()
    g = h[..., D:].clone()
    z = torch.tanh(f) * _sigmoid(g)
    return z @ w_o
```

```asm
; @launch kernel=prep_kernel grid=(243,1,1) block=(128,1,1) lds=0
; @launch kernel=standalone__autoregressive_conv_wavenet__speech_kernel grid=(251,1,1) block=(256,1,1) lds=163840
.amdgcn_target "amdgcn-amd-amdhsa--gfx950"
.text
.globl standalone__autoregressive_conv_wavenet__speech_kernel
.p2align 8
.type standalone__autoregressive_conv_wavenet__speech_kernel,@function
standalone__autoregressive_conv_wavenet__speech_kernel:
s_cmp_ge_u32 s2, 251
s_cbranch_scc1 L_end
s_load_dwordx4 s[4:7], s[0:1], 0
s_load_dwordx4 s[12:15], s[0:1], 32
s_load_dwordx4 s[8:11], s[0:1], 16
s_and_b32 s36, s2, 7
s_lshr_b32 s2, s2, 3
s_lshr_b32 s37, 5, s36
s_and_b32 s37, s37, 1
s_add_u32 s37, s37, 31
s_cmp_ge_u32 s2, s37
s_cbranch_scc1 L_endw
s_bfm_b32 s37, s36, 0
s_and_b32 s37, s37, 5
s_bcnt1_i32_b32 s37, s37
s_mul_i32 s36, s36, 31
s_add_u32 s2, s2, s37
s_add_u32 s2, s2, s36
v_lshrrev_b32 v1, 6, v0
s_cmp_ge_u32 s2, 125
s_cselect_b32 s36, 125, 0
s_cselect_b32 s37, 4608000, 0
v_readfirstlane_b32 s3, v1
v_and_b32 v1, 63, v0
s_sub_u32 s36, s2, s36
s_mul_i32 s36, s36, 36864
s_sub_u32 s36, s36, 8064
v_lshlrev_b32 v129, 4, v0
v_add_u32 v129, s36, v129
s_movk_i32 s38, 576
s_lshl_b32 s39, s3, 10
v_mul_u32_u24 v130, 1821, v0
v_lshrrev_b32 v130, 16, v130
v_mad_u32_u24 v132, v130, s38, v129
v_add_u32 v130, 256, v0
v_mul_u32_u24 v130, 1821, v130
v_lshrrev_b32 v130, 16, v130
v_mad_u32_u24 v133, v130, s38, v129
v_add_u32 v133, 4096, v133
v_add_u32 v130, 512, v0
v_mul_u32_u24 v130, 1821, v130
v_lshrrev_b32 v130, 16, v130
v_mad_u32_u24 v134, v130, s38, v129
v_add_u32 v134, 8192, v134
v_add_u32 v130, 768, v0
v_mul_u32_u24 v130, 1821, v130
v_lshrrev_b32 v130, 16, v130
v_mad_u32_u24 v135, v130, s38, v129
v_add_u32 v135, 12288, v135
v_add_u32 v130, 1024, v0
v_mul_u32_u24 v130, 1821, v130
v_lshrrev_b32 v130, 16, v130
v_mad_u32_u24 v136, v130, s38, v129
v_add_u32 v136, 16384, v136
v_add_u32 v130, 1280, v0
v_mul_u32_u24 v130, 1821, v130
v_lshrrev_b32 v130, 16, v130
v_mad_u32_u24 v137, v130, s38, v129
v_add_u32 v137, 20480, v137
s_mul_i32 s36, s3, 382976
s_sub_u32 s84, 1531904, s36
v_lshlrev_b32 v12, 4, v1
v_add_u32 v12, s36, v12
v_add_u32 v13, 4096, v12
v_add_u32 v14, 8192, v12
v_add_u32 v15, 12288, v12
v_cmp_lt_u32 vcc, 31, v1
v_mov_b32 v130, 0x7f000000
s_mov_b32 s18, 4608000
s_mov_b32 s19, 0x20000
v_cndmask_b32 v102, v13, v130, vcc
v_cndmask_b32 v103, v14, v130, vcc
s_mov_b32 s26, 1538048
s_mov_b32 s27, 0x20000
s_mov_b32 s40, 0
s_add_u32 m0, s39, 0
s_waitcnt lgkmcnt(0)
s_add_u32 s16, s4, s37
s_addc_u32 s17, s5, 0
s_add_u32 s24, s14, 1048576
s_addc_u32 s25, s15, 0
s_cmp_ge_u32 s3, 2
s_cbranch_scc1 L_xdone
s_add_u32 m0, s39, 20480
s_nop 0
buffer_load_dwordx4 v137, s[16:19], 0 offen lds
s_add_u32 m0, s39, 43040
s_nop 0
buffer_load_dwordx4 v137, s[16:19], s38 offen lds
L_xdone:
s_add_u32 m0, s39, 0
s_nop 0
buffer_load_dwordx4 v132, s[16:19], 0 offen lds
s_add_u32 m0, s39, 22560
s_nop 0
buffer_load_dwordx4 v132, s[16:19], s38 offen lds
s_add_u32 m0, s39, 4096
s_nop 0
buffer_load_dwordx4 v133, s[16:19], 0 offen lds
s_add_u32 m0, s39, 26656
s_nop 0
buffer_load_dwordx4 v133, s[16:19], s38 offen lds
s_add_u32 m0, s39, 8192
s_nop 0
buffer_load_dwordx4 v134, s[16:19], 0 offen lds
s_add_u32 m0, s39, 30752
s_nop 0
buffer_load_dwordx4 v134, s[16:19], s38 offen lds
s_add_u32 m0, s39, 12288
s_nop 0
buffer_load_dwordx4 v135, s[16:19], 0 offen lds
s_add_u32 m0, s39, 34848
s_nop 0
buffer_load_dwordx4 v135, s[16:19], s38 offen lds
s_add_u32 m0, s39, 16384
s_nop 0
buffer_load_dwordx4 v136, s[16:19], 0 offen lds
s_add_u32 m0, s39, 38944
s_nop 0
buffer_load_dwordx4 v136, s[16:19], s38 offen lds
s_mov_b32 s28, s10
s_mov_b32 s29, s11
s_mov_b32 s30, 9216000
s_mov_b32 s31, 0x20000
s_and_b32 s13, s3, 1
s_mov_b32 s12, 0x42700000
s_cmp_eq_u32 s13, 0
s_mov_b32 s4, 0x3f800000
s_cmov_b32 s4, 0xbf800000
s_mov_b32 s5, 0xbf000000
s_cmov_b32 s5, 0x3f000000
s_mov_b32 s6, 0xbf160000
s_cmov_b32 s6, 0xbe160000
s_mov_b32 s7, 0xbe5a740e
s_cmov_b32 s7, 0xbf5a740e
s_mov_b32 s8, 0x3f700000
s_cmov_b32 s8, 0x3e700000
s_mov_b32 s9, 0x3f19999a
s_cmov_b32 s9, 0x4019999a
s_mov_b32 s10, 0xbf800000
s_cmov_b32 s10, 0x3e800000
s_mov_b32 s11, 0x3f000000
s_cmov_b32 s11, 0xc0000000
s_mov_b32 s78, 0x3f610000
s_cmov_b32 s78, 0x3e610000
s_mov_b32 s79, 0x3f2aaaab
s_mov_b32 s80, 0xbf000000
s_cmov_b32 s80, 0xbf800000
s_mov_b32 s81, 0xbf800000
s_cmov_b32 s81, 0xc0000000
s_mov_b32 s82, 0xbeaaaaab
s_cmov_b32 s82, 0x3f2aaaab
s_mov_b32 s83, 0x3eaaaaab
s_cmov_b32 s83, 0x3f2aaaab
s_xor_b32 s36, s3, 0
s_lshl_b32 s37, s2, 7
s_add_u32 s37, s36, s37
s_mul_i32 s37, s37, 288
s_lshl_b32 s36, s13, 7
s_add_u32 s92, s37, s36
s_add_u32 s94, s92, 18432
s_add_u32 s96, s37, 256
s_add_u32 s97, s96, 18432
s_xor_b32 s36, s3, 1
s_lshl_b32 s37, s2, 7
s_add_u32 s37, s36, s37
s_mul_i32 s37, s37, 288
s_lshl_b32 s36, s13, 7
s_add_u32 s93, s37, s36
s_add_u32 s95, s93, 18432
v_and_b32 v105, 15, v1
v_mul_u32_u24 v105, 288, v105
v_bfe_u32 v106, v1, 4, 1
v_lshl_add_u32 v105, v106, 4, v105
v_lshrrev_b32 v106, 5, v1
s_mov_b32 s36, 0x20
s_mul_i32 s37, s13, 0x5110
s_add_u32 s37, s37, 0x40
v_mad_i32_i24 v2, v106, s36, v105
v_add_u32 v2, s37, v2
s_mov_b32 s36, 0xfffff600
s_mul_i32 s37, s13, 0x5110
s_add_u32 s37, s37, 0xa20
v_mad_i32_i24 v3, v106, s36, v105
v_add_u32 v3, s37, v3
s_mov_b32 s36, 0x20
s_mul_i32 s37, s13, 0xffffaef0
s_add_u32 s37, s37, 0x5150
v_mad_i32_i24 v4, v106, s36, v105
v_add_u32 v4, s37, v4
s_mov_b32 s36, 0xfffff600
s_mul_i32 s37, s13, 0xffffaef0
s_add_u32 s37, s37, 0x5b30
v_mad_i32_i24 v5, v106, s36, v105
v_add_u32 v5, s37, v5
s_mov_b32 s36, 0x20
s_mul_i32 s37, s13, 0x5110
s_add_u32 s37, s37, 0x15480
v_mad_i32_i24 v6, v106, s36, v105
v_add_u32 v6, s37, v6
s_mov_b32 s36, 0xfffff600
s_mul_i32 s37, s13, 0x5110
s_add_u32 s37, s37, 0x15e60
v_mad_i32_i24 v7, v106, s36, v105
v_add_u32 v7, s37, v7
s_mov_b32 s36, 0x20
s_mul_i32 s37, s13, 0xffffaef0
s_add_u32 s37, s37, 0x1a590
v_mad_i32_i24 v8, v106, s36, v105
v_add_u32 v8, s37, v8
s_mov_b32 s36, 0xfffff600
s_mul_i32 s37, s13, 0xffffaef0
s_add_u32 s37, s37, 0x1af70
v_mad_i32_i24 v9, v106, s36, v105
v_add_u32 v9, s37, v9
s_mov_b32 s36, 0x20
s_mul_i32 s37, s13, 0xffffaa20
s_add_u32 s37, s37, 0x5ee0
v_mad_i32_i24 v96, v106, s36, v105
v_add_u32 v96, s37, v96
s_mov_b32 s36, 0x20
s_mul_i32 s37, s13, 0x55e0
s_add_u32 s37, s37, 0x900
v_mad_i32_i24 v97, v106, s36, v105
v_add_u32 v97, s37, v97
v_bfe_u32 v105, v1, 2, 1
v_mul_u32_u24 v105, 22560, v105
v_bfe_u32 v106, v1, 3, 2
v_lshrrev_b32 v107, 5, v1
v_lshl_add_u32 v106, v107, 3, v106
v_mul_u32_u24 v106, 576, v106
v_and_b32 v107, 3, v1
v_lshlrev_b32 v108, 3, v107
v_add3_u32 v105, v105, v106, v108
s_lshr_b32 s38, s3, 1
s_mul_i32 s39, s13, 288
s_lshl_b32 s36, s38, 7
s_add_u32 s36, s36, s39
s_mul_i32 s37, s38, 6912
s_add_u32 s37, s37, s39
s_add_u32 s37, s37, 256
s_mul_i32 s38, s38, 576
v_cmp_le_u32 vcc, 56, v1
v_add_u32 v98, s36, v105
v_add_u32 v100, s37, v105
v_subrev_u32 v106, 576, v98
v_subrev_u32 v108, s38, v100
v_cndmask_b32 v99, v98, v106, vcc
v_cndmask_b32 v101, v100, v108, vcc
v_mul_u32_u24 v107, 576, v107
v_lshrrev_b32 v106, 4, v1
v_lshl_add_u32 v107, v106, 3, v107
v_bfe_u32 v105, v1, 2, 1
v_mul_u32_u24 v105, 20752, v105
v_add_u32 v107, v107, v105
v_bfe_u32 v106, v1, 3, 1
v_mul_u32_u24 v105, 41504, v106
v_mul_u32_u24 v106, 45600, v106
v_add_u32 v105, 45632, v105
v_add_u32 v106, 32, v106
v_add3_u32 v16, v107, v105, s36
v_add3_u32 v17, v107, v105, s37
v_add3_u32 v10, v107, v106, s36
v_add3_u32 v11, v107, v106, s37
buffer_load_dwordx4 v[76:79], v12, s[24:27], s84 offen offset:0
buffer_load_dwordx4 v[80:83], v12, s[24:27], s84 offen offset:1024
buffer_load_dwordx4 v[84:87], v12, s[24:27], s84 offen offset:2048
buffer_load_dwordx4 a[64:67], v12, s[24:27], s40 offen offset:0
buffer_load_dwordx4 a[68:71], v12, s[24:27], s40 offen offset:1024
s_lshr_b32 s41, s2, 0
s_mov_b32 s42, 2
s_mov_b64 exec, 0
s_mul_i32 s43, s41, 32769
s_lshr_b32 s43, s43, 16
s_mul_i32 s43, s43, 2
s_sub_u32 s41, s41, s43
s_lshl_b32 s41, s41, 2
s_add_u32 s41, s41, s3
s_mov_b32 s35, 0
L_wret:
s_cmp_lg_u32 s35, 0
s_cbranch_scc1 L_phub
s_sub_u32 s42, s42, 1
s_cbranch_scc1 L_wdone
s_add_u32 s41, s41, 4
s_cmp_ge_u32 s41, 8
s_cselect_b32 s43, 8, 0
s_sub_u32 s41, s41, s43
s_cmp_eq_u32 s41, 0
s_cbranch_scc1 L_isl0
s_cmp_eq_u32 s41, 1
s_cbranch_scc1 L_isl1
s_cmp_eq_u32 s41, 2
s_cbranch_scc1 L_isl2
s_cmp_eq_u32 s41, 3
s_cbranch_scc1 L_isl3
s_cmp_eq_u32 s41, 4
s_cbranch_scc1 L_isl4
s_cmp_eq_u32 s41, 5
s_cbranch_scc1 L_isl5
s_cmp_eq_u32 s41, 6
s_cbranch_scc1 L_isl6
s_cmp_eq_u32 s41, 7
s_cbranch_scc1 L_isl7
s_branch L_wret
L_wdone:
s_mov_b64 exec, -1
buffer_load_dwordx4 a[72:75], v12, s[24:27], s40 offen offset:2048
buffer_load_dwordx4 a[76:79], v12, s[24:27], s40 offen offset:3072
buffer_load_dwordx4 a[80:83], v13, s[24:27], s40 offen offset:0
s_waitcnt vmcnt(8)
s_barrier
s_branch L_go
.p2align 12
L_go:
L_isl0:
s_cbranch_execz L_wret
ds_read_b64_tr_b16 v[20:21], v98 offset:0
ds_read_b64_tr_b16 v[22:23], v98 offset:2304
ds_read_b128 a[0:3], v96 offset:0
ds_read_b128 a[4:7], v96 offset:4608
ds_read_b128 a[8:11], v96 offset:9216
ds_read_b128 a[12:15], v96 offset:13824
ds_read_b64_tr_b16 v[24:25], v98 offset:32
ds_read_b64_tr_b16 v[26:27], v98 offset:2336
s_waitcnt vmcnt(5) lgkmcnt(6)
v_mfma_f32_16x16x32_bf16 v[88:91], v[20:23], v[76:79], 0
buffer_load_dwordx4 a[84:87], v13, s[24:27], s40 offen offset:1024
ds_read_b64_tr_b16 v[28:29], v98 offset:64
v_mfma_f32_16x16x32_bf16 v[92:95], v[20:23], v[80:83], 0
ds_read_b64_tr_b16 v[30:31], v98 offset:2368
v_mfma_f32_16x16x32_bf16 v[104:107], v[20:23], v[84:87], 0
s_waitcnt vmcnt(5) lgkmcnt(7)
v_mfma_f32_16x16x32_bf16 v[128:131], a[64:67], a[0:3], 0
ds_read_b128 a[16:19], v97 offset:0
ds_read_b128 a[20:23], v97 offset:4608
s_waitcnt lgkmcnt(8)
v_mfma_f32_16x16x32_bf16 v[132:135], a[64:67], a[4:7], 0
ds_read_b128 a[24:27], v97 offset:9216
ds_read_b128 a[28:31], v97 offset:13824
s_waitcnt lgkmcnt(9)
v_mfma_f32_16x16x32_bf16 v[136:139], a[64:67], a[8:11], 0
buffer_load_dwordx4 a[88:91], v13, s[24:27], s40 offen offset:2048
v_cvt_pk_bf16_f32 v88, v88, v89
s_waitcnt lgkmcnt(6)
v_mfma_f32_16x16x32_bf16 v[108:111], v[24:27], v[76:79], 0
ds_read_b64_tr_b16 v[32:33], v98 offset:96
ds_read_b64_tr_b16 v[34:35], v98 offset:2400
v_mfma_f32_16x16x32_bf16 v[140:143], a[64:67], a[12:15], 0
v_cvt_pk_bf16_f32 v89, v90, v91
s_waitcnt vmcnt(5)
v_mfma_f32_16x16x32_bf16 v[156:159], a[68:71], a[12:15], 0
ds_write_b64 v16, v[88:89] offset:0
v_mfma_f32_16x16x32_bf16 v[152:155], a[68:71], a[8:11], 0
buffer_load_dwordx4 a[92:95], v13, s[24:27], s40 offen offset:3072
v_cvt_pk_bf16_f32 v92, v92, v93
v_mfma_f32_16x16x32_bf16 v[88:91], v[24:27], v[80:83], 0
v_cvt_pk_bf16_f32 v93, v94, v95
v_mfma_f32_16x16x32_bf16 v[148:151], a[68:71], a[4:7], 0
ds_write_b64 v16, v[92:93] offset:2304
v_mfma_f32_16x16x32_bf16 v[144:147], a[68:71], a[0:3], 0
v_cvt_pk_bf16_f32 v104, v104, v105
v_cvt_pk_bf16_f32 v105, v106, v107
s_waitcnt vmcnt(5)
v_mfma_f32_16x16x32_bf16 v[112:115], a[72:75], a[0:3], 0
ds_write_b64 v16, v[104:105] offset:4608
v_mfma_f32_16x16x32_bf16 v[92:95], v[24:27], v[84:87], 0
buffer_load_dwordx4 a[96:99], v14, s[24:27], s40 offen offset:0
v_cvt_pk_bf16_f32 v108, v108, v109
v_mfma_f32_16x16x32_bf16 v[116:119], a[72:75], a[4:7], 0
v_cvt_pk_bf16_f32 v109, v110, v111
v_mfma_f32_16x16x32_bf16 v[120:123], a[72:75], a[8:11], 0
ds_write_b64 v16, v[108:109] offset:32
v_mfma_f32_16x16x32_bf16 v[124:127], a[72:75], a[12:15], 0
v_cvt_pk_bf16_f32 v88, v88, v89
v_cvt_pk_bf16_f32 v89, v90, v91
s_waitcnt lgkmcnt(10)
v_mfma_f32_16x16x32_bf16 v[104:107], v[28:31], v[76:79], 0
buffer_load_dwordx4 a[100:103], v14, s[24:27], s40 offen offset:1024
ds_read_b64_tr_b16 v[36:37], v98 offset:6912
s_waitcnt vmcnt(6)
v_mfma_f32_16x16x32_bf16 v[172:175], a[76:79], a[12:15], 0
ds_read_b64_tr_b16 v[38:39], v98 offset:9216
v_mfma_f32_16x16x32_bf16 v[168:171], a[76:79], a[8:11], 0
ds_write_b64 v16, v[88:89] offset:2336
v_mfma_f32_16x16x32_bf16 v[164:167], a[76:79], a[4:7], 0
v_cvt_pk_bf16_f32 v92, v92, v93
v_cvt_pk_bf16_f32 v93, v94, v95
v_mfma_f32_16x16x32_bf16 v[108:111], v[28:31], v[80:83], 0
ds_write_b64 v16, v[92:93] offset:4640
v_mfma_f32_16x16x32_bf16 v[160:163], a[76:79], a[0:3], 0
buffer_load_dwordx4 a[104:107], v14, s[24:27], s40 offen offset:2048
v_cvt_pk_bf16_f32 v104, v104, v105
s_waitcnt vmcnt(6)
v_mfma_f32_16x16x32_bf16 v[176:179], a[80:83], a[0:3], 0
v_cvt_pk_bf16_f32 v105, v106, v107
v_mfma_f32_16x16x32_bf16 v[180:183], a[80:83], a[4:7], 0
ds_write_b64 v16, v[104:105] offset:64
v_mfma_f32_16x16x32_bf16 v[88:91], v[28:31], v[84:87], 0
v_cvt_pk_bf16_f32 v108, v108, v109
v_cvt_pk_bf16_f32 v109, v110, v111
v_mfma_f32_16x16x32_bf16 v[184:187], a[80:83], a[8:11], 0
buffer_load_dwordx4 a[108:111], v14, s[24:27], s40 offen offset:3072
v_mfma_f32_16x16x32_bf16 v[188:191], a[80:83], a[12:15], 0
s_waitcnt lgkmcnt(11)
ds_write_b64 v16, v[108:109] offset:2368
v_mfma_f32_16x16x32_bf16 v[192:195], a[64:67], a[16:19], 0
ds_read_b128 a[32:35], v96 offset:64
ds_read_b128 a[36:39], v96 offset:4672
s_waitcnt lgkmcnt(12)
v_mfma_f32_16x16x32_bf16 v[92:95], v[32:35], v[76:79], 0
ds_read_b128 a[40:43], v96 offset:9280
ds_read_b128 a[44:47], v96 offset:13888
v_mfma_f32_16x16x32_bf16 v[196:199], a[64:67], a[20:23], 0
ds_read_b64_tr_b16 v[40:41], v98 offset:6944
ds_read_b64_tr_b16 v[42:43], v98 offset:9248
v_mfma_f32_16x16x32_bf16 v[200:203], a[64:67], a[24:27], 0
buffer_load_dwordx4 a[112:115], v15, s[24:27], s40 offen offset:0
v_cvt_pk_bf16_f32 v88, v88, v89
v_mfma_f32_16x16x32_bf16 v[204:207], a[64:67], a[28:31], 0
v_cvt_pk_bf16_f32 v89, v90, v91
v_mfma_f32_16x16x32_bf16 v[104:107], v[32:35], v[80:83], 0
ds_write_b64 v16, v[88:89] offset:4672
v_mfma_f32_16x16x32_bf16 v[220:223], a[68:71], a[28:31], 0
v_cvt_pk_bf16_f32 v92, v92, v93
v_cvt_pk_bf16_f32 v93, v94, v95
v_mfma_f32_16x16x32_bf16 v[216:219], a[68:71], a[24:27], 0
buffer_load_dwordx4 a[116:119], v15, s[24:27], s40 offen offset:1024
v_mfma_f32_16x16x32_bf16 v[212:215], a[68:71], a[20:23], 0
ds_write_b64 v16, v[92:93] offset:96
v_mfma_f32_16x16x32_bf16 v[108:111], v[32:35], v[84:87], 0
v_cvt_pk_bf16_f32 v104, v104, v105
v_cvt_pk_bf16_f32 v105, v106, v107
v_mfma_f32_16x16x32_bf16 v[208:211], a[68:71], a[16:19], 0
ds_write_b64 v16, v[104:105] offset:2400
v_mfma_f32_16x16x32_bf16 v[224:227], a[76:79], a[16:19], 0
v_mfma_f32_16x16x32_bf16 v[228:231], a[76:79], a[20:23], 0
buffer_load_dwordx4 a[120:123], v15, s[24:27], s40 offen offset:2048
s_waitcnt lgkmcnt(13)
v_mfma_f32_16x16x32_bf16 v[88:91], v[36:39], v[76:79], 0
ds_read_b64_tr_b16 v[44:45], v98 offset:6976
ds_read_b64_tr_b16 v[46:47], v98 offset:9280
v_mfma_f32_16x16x32_bf16 v[232:235], a[76:79], a[24:27], 0
v_cvt_pk_bf16_f32 v108, v108, v109
v_cvt_pk_bf16_f32 v109, v110, v111
v_mfma_f32_16x16x32_bf16 v[236:239], a[76:79], a[28:31], 0
ds_write_b64 v16, v[108:109] offset:4704
v_mfma_f32_16x16x32_bf16 v[252:255], a[80:83], a[28:31], 0
buffer_load_dwordx4 a[124:127], v15, s[24:27], s40 offen offset:3072
v_mfma_f32_16x16x32_bf16 v[92:95], v[36:39], v[80:83], 0
v_cvt_pk_bf16_f32 v88, v88, v89
v_cvt_pk_bf16_f32 v89, v90, v91
v_mfma_f32_16x16x32_bf16 v[248:251], a[80:83], a[24:27], 0
ds_write_b64 v16, v[88:89] offset:6912
v_mfma_f32_16x16x32_bf16 v[244:247], a[80:83], a[20:23], 0
v_mfma_f32_16x16x32_bf16 v[240:243], a[80:83], a[16:19], 0
s_waitcnt vmcnt(6) lgkmcnt(9)
v_mfma_f32_16x16x32_bf16 v[128:131], a[84:87], a[32:35], v[128:131]
s_add_u32 s40, s40, 16384
buffer_load_dwordx4 a[128:131], v12, s[24:27], s40 offen offset:0
ds_read_b128 a[48:51], v97 offset:64
v_mfma_f32_16x16x32_bf16 v[104:107], v[36:39], v[84:87], 0
ds_read_b128 a[52:55], v97 offset:4672
ds_read_b128 a[56:59], v97 offset:9280
v_mfma_f32_16x16x32_bf16 v[132:135], a[84:87], a[36:39], v[132:135]
ds_read_b128 a[60:63], v97 offset:13888
v_cvt_pk_bf16_f32 v92, v92, v93
v_mfma_f32_16x16x32_bf16 v[136:139], a[84:87], a[40:43], v[136:139]
v_cvt_pk_bf16_f32 v93, v94, v95
v_mfma_f32_16x16x32_bf16 v[140:143], a[84:87], a[44:47], v[140:143]
buffer_load_dwordx4 a[132:135], v12, s[24:27], s40 offen offset:1024
s_waitcnt lgkmcnt(11)
v_mfma_f32_16x16x32_bf16 v[108:111], v[40:43], v[76:79], 0
ds_read_b64_tr_b16 v[48:49], v98 offset:7008
ds_read_b64_tr_b16 v[50:51], v98 offset:9312
v_mfma_f32_16x16x32_bf16 v[156:159], a[88:91], a[44:47], v[156:159]
ds_write_b64 v16, v[92:93] offset:9216
v_mfma_f32_16x16x32_bf16 v[152:155], a[88:91], a[40:43], v[152:155]
v_cvt_pk_bf16_f32 v104, v104, v105
v_cvt_pk_bf16_f32 v105, v106, v107
v_mfma_f32_16x16x32_bf16 v[148:151], a[88:91], a[36:39], v[148:151]
ds_write_b64 v16, v[104:105] offset:11520
v_mfma_f32_16x16x32_bf16 v[88:91], v[40:43], v[80:83], 0
buffer_load_dwordx4 a[136:139], v12, s[24:27], s40 offen offset:2048
v_cvt_pk_bf16_f32 v108, v108, v109
v_mfma_f32_16x16x32_bf16 v[144:147], a[88:91], a[32:35], v[144:147]
v_cvt_pk_bf16_f32 v109, v110, v111
v_mfma_f32_16x16x32_bf16 v[112:115], a[92:95], a[32:35], v[112:115]
ds_write_b64 v16, v[108:109] offset:6944
v_mfma_f32_16x16x32_bf16 v[116:119], a[92:95], a[36:39], v[116:119]
v_mfma_f32_16x16x32_bf16 v[92:95], v[40:43], v[84:87], 0
buffer_load_dwordx4 a[140:143], v12, s[24:27], s40 offen offset:3072
v_cvt_pk_bf16_f32 v88, v88, v89
v_mfma_f32_16x16x32_bf16 v[120:123], a[92:95], a[40:43], v[120:123]
v_cvt_pk_bf16_f32 v89, v90, v91
v_mfma_f32_16x16x32_bf16 v[124:127], a[92:95], a[44:47], v[124:127]
ds_write_b64 v16, v[88:89] offset:9248
v_mfma_f32_16x16x32_bf16 v[172:175], a[96:99], a[44:47], v[172:175]
s_waitcnt lgkmcnt(12)
v_mfma_f32_16x16x32_bf16 v[104:107], v[44:47], v[76:79], 0
ds_read_b64_tr_b16 v[52:53], v98 offset:13824
ds_read_b64_tr_b16 v[54:55], v99 offset:16128
v_mfma_f32_16x16x32_bf16 v[168:171], a[96:99], a[40:43], v[168:171]
buffer_load_dwordx4 a[144:147], v102, s[24:27], s40 offen offset:0
v_cvt_pk_bf16_f32 v92, v92, v93
v_mfma_f32_16x16x32_bf16 v[164:167], a[96:99], a[36:39], v[164:167]
v_cvt_pk_bf16_f32 v93, v94, v95
v_mfma_f32_16x16x32_bf16 v[160:163], a[96:99], a[32:35], v[160:163]
ds_write_b64 v16, v[92:93] offset:11552
v_mfma_f32_16x16x32_bf16 v[108:111], v[44:47], v[80:83], 0
v_cvt_pk_bf16_f32 v104, v104, v105
v_cvt_pk_bf16_f32 v105, v106, v107
v_mfma_f32_16x16x32_bf16 v[176:179], a[100:103], a[32:35], v[176:179]
buffer_load_dwordx4 a[148:151], v102, s[24:27], s40 offen offset:1024
v_mfma_f32_16x16x32_bf16 v[180:183], a[100:103], a[36:39], v[180:183]
ds_write_b64 v16, v[104:105] offset:6976
v_mfma_f32_16x16x32_bf16 v[184:187], a[100:103], a[40:43], v[184:187]
v_mfma_f32_16x16x32_bf16 v[88:91], v[44:47], v[84:87], 0
v_cvt_pk_bf16_f32 v108, v108, v109
v_cvt_pk_bf16_f32 v109, v110, v111
v_mfma_f32_16x16x32_bf16 v[188:191], a[100:103], a[44:47], v[188:191]
s_waitcnt lgkmcnt(10)
buffer_load_dwordx4 a[152:155], v102, s[24:27], s40 offen offset:2048
v_mfma_f32_16x16x32_bf16 v[192:195], a[84:87], a[48:51], v[192:195]
ds_read_b128 a[0:3], v96 offset:128
ds_read_b128 a[4:7], v96 offset:4736
v_mfma_f32_16x16x32_bf16 v[196:199], a[84:87], a[52:55], v[196:199]
ds_read_b128 a[8:11], v96 offset:9344
ds_read_b128 a[12:15], v96 offset:13952
s_waitcnt lgkmcnt(12)
v_mfma_f32_16x16x32_bf16 v[92:95], v[48:51], v[76:79], 0
ds_read_b64_tr_b16 v[56:57], v98 offset:13856
ds_read_b64_tr_b16 v[58:59], v99 offset:16160
v_mfma_f32_16x16x32_bf16 v[200:203], a[84:87], a[56:59], v[200:203]
ds_write_b64 v16, v[108:109] offset:9280
v_mfma_f32_16x16x32_bf16 v[204:207], a[84:87], a[60:63], v[204:207]
buffer_load_dwordx4 a[156:159], v102, s[24:27], s40 offen offset:3072
v_cvt_pk_bf16_f32 v88, v88, v89
v_mfma_f32_16x16x32_bf16 v[220:223], a[88:91], a[60:63], v[220:223]
v_cvt_pk_bf16_f32 v89, v90, v91
v_mfma_f32_16x16x32_bf16 v[104:107], v[48:51], v[80:83], 0
ds_write_b64 v16, v[88:89] offset:11584
v_mfma_f32_16x16x32_bf16 v[216:219], a[88:91], a[56:59], v[216:219]
v_cvt_pk_bf16_f32 v92, v92, v93
v_cvt_pk_bf16_f32 v93, v94, v95
v_mfma_f32_16x16x32_bf16 v[212:215], a[88:91], a[52:55], v[212:215]
buffer_load_dwordx4 a[160:163], v103, s[24:27], s40 offen offset:0
v_mfma_f32_16x16x32_bf16 v[208:211], a[88:91], a[48:51], v[208:211]
ds_write_b64 v16, v[92:93] offset:7008
v_mfma_f32_16x16x32_bf16 v[108:111], v[48:51], v[84:87], 0
v_cvt_pk_bf16_f32 v104, v104, v105
v_cvt_pk_bf16_f32 v105, v106, v107
v_mfma_f32_16x16x32_bf16 v[224:227], a[96:99], a[48:51], v[224:227]
ds_write_b64 v16, v[104:105] offset:9312
v_mfma_f32_16x16x32_bf16 v[228:231], a[96:99], a[52:55], v[228:231]
v_mfma_f32_16x16x32_bf16 v[232:235], a[96:99], a[56:59], v[232:235]
buffer_load_dwordx4 a[164:167], v14, s[24:27], s40 offen offset:1024
s_waitcnt lgkmcnt(12)
v_mfma_f32_16x16x32_bf16 v[88:91], v[52:55], v[76:79], 0
ds_read_b64_tr_b16 v[60:61], v98 offset:13888
ds_read_b64_tr_b16 v[62:63], v99 offset:16192
v_mfma_f32_16x16x32_bf16 v[236:239], a[96:99], a[60:63], v[236:239]
v_cvt_pk_bf16_f32 v108, v108, v109
v_cvt_pk_bf16_f32 v109, v110, v111
v_mfma_f32_16x16x32_bf16 v[252:255], a[100:103], a[60:63], v[252:255]
ds_write_b64 v16, v[108:109] offset:11616
v_mfma_f32_16x16x32_bf16 v[248:251], a[100:103], a[56:59], v[248:251]
buffer_load_dwordx4 a[168:171], v14, s[24:27], s40 offen offset:2048
v_mfma_f32_16x16x32_bf16 v[92:95], v[52:55], v[80:83], 0
v_cvt_pk_bf16_f32 v88, v88, v89
v_cvt_pk_bf16_f32 v89, v90, v91
v_mfma_f32_16x16x32_bf16 v[244:247], a[100:103], a[52:55], v[244:247]
ds_write_b64 v16, v[88:89] offset:13824
v_mfma_f32_16x16x32_bf16 v[240:243], a[100:103], a[48:51], v[240:243]
s_waitcnt vmcnt(12) lgkmcnt(10)
v_mfma_f32_16x16x32_bf16 v[128:131], a[104:107], a[0:3], v[128:131]
ds_read_b128 a[16:19], v96 offset:192
ds_read_b128 a[20:23], v96 offset:4800
v_mfma_f32_16x16x32_bf16 v[104:107], v[52:55], v[84:87], 0
buffer_load_dwordx4 a[172:175], v14, s[24:27], s40 offen offset:3072
ds_read_b128 a[24:27], v96 offset:9408
v_mfma_f32_16x16x32_bf16 v[132:135], a[104:107], a[4:7], v[132:135]
ds_read_b128 a[28:31], v96 offset:14016
v_cvt_pk_bf16_f32 v92, v92, v93
v_mfma_f32_16x16x32_bf16 v[136:139], a[104:107], a[8:11], v[136:139]
v_cvt_pk_bf16_f32 v93, v94, v95
v_mfma_f32_16x16x32_bf16 v[140:143], a[104:107], a[12:15], v[140:143]
ds_write_b64 v16, v[92:93] offset:16128
s_waitcnt lgkmcnt(13)
v_mfma_f32_16x16x32_bf16 v[108:111], v[56:59], v[76:79], 0
buffer_load_dwordx4 a[176:179], v15, s[24:27], s40 offen offset:0
ds_read_b64_tr_b16 v[64:65], v98 offset:13920
v_mfma_f32_16x16x32_bf16 v[156:159], a[108:111], a[12:15], v[156:159]
ds_read_b64_tr_b16 v[66:67], v99 offset:16224
v_cvt_pk_bf16_f32 v104, v104, v105
v_mfma_f32_16x16x32_bf16 v[152:155], a[108:111], a[8:11], v[152:155]
v_cvt_pk_bf16_f32 v105, v106, v107
v_mfma_f32_16x16x32_bf16 v[148:151], a[108:111], a[4:7], v[148:151]
ds_write_b64 v16, v[104:105] offset:18432
v_mfma_f32_16x16x32_bf16 v[88:91], v[56:59], v[80:83], 0
v_cvt_pk_bf16_f32 v108, v108, v109
v_cvt_pk_bf16_f32 v109, v110, v111
v_mfma_f32_16x16x32_bf16 v[144:147], a[108:111], a[0:3], v[144:147]
buffer_load_dwordx4 a[180:183], v15, s[24:27], s40 offen offset:1024
v_mfma_f32_16x16x32_bf16 v[112:115], a[112:115], a[0:3], v[112:115]
ds_write_b64 v16, v[108:109] offset:13856
v_mfma_f32_16x16x32_bf16 v[116:119], a[112:115], a[4:7], v[116:119]
v_mfma_f32_16x16x32_bf16 v[92:95], v[56:59], v[84:87], 0
v_cvt_pk_bf16_f32 v88, v88, v89
v_cvt_pk_bf16_f32 v89, v90, v91
v_mfma_f32_16x16x32_bf16 v[120:123], a[112:115], a[8:11], v[120:123]
buffer_load_dwordx4 a[184:187], v15, s[24:27], s40 offen offset:2048
v_mfma_f32_16x16x32_bf16 v[124:127], a[112:115], a[12:15], v[124:127]
ds_write_b64 v16, v[88:89] offset:16160
v_mfma_f32_16x16x32_bf16 v[172:175], a[116:119], a[12:15], v[172:175]
s_waitcnt lgkmcnt(12)
v_mfma_f32_16x16x32_bf16 v[104:107], v[60:63], v[76:79], 0
ds_read_b64_tr_b16 v[68:69], v100 offset:0
ds_read_b64_tr_b16 v[70:71], v100 offset:2304
v_mfma_f32_16x16x32_bf16 v[168:171], a[116:119], a[8:11], v[168:171]
v_cvt_pk_bf16_f32 v92, v92, v93
v_cvt_pk_bf16_f32 v93, v94, v95
v_mfma_f32_16x16x32_bf16 v[164:167], a[116:119], a[4:7], v[164:167]
buffer_load_dwordx4 a[188:191], v15, s[24:27], s40 offen offset:3072
v_mfma_f32_16x16x32_bf16 v[160:163], a[116:119], a[0:3], v[160:163]
ds_write_b64 v16, v[92:93] offset:18464
v_mfma_f32_16x16x32_bf16 v[108:111], v[60:63], v[80:83], 0
v_cvt_pk_bf16_f32 v104, v104, v105
v_cvt_pk_bf16_f32 v105, v106, v107
v_mfma_f32_16x16x32_bf16 v[176:179], a[120:123], a[0:3], v[176:179]
ds_write_b64 v16, v[104:105] offset:13888
v_mfma_f32_16x16x32_bf16 v[180:183], a[120:123], a[4:7], v[180:183]
s_add_u32 s40, s40, 16384
buffer_load_dwordx4 a[192:195], v12, s[24:27], s40 offen offset:0
v_mfma_f32_16x16x32_bf16 v[184:187], a[120:123], a[8:11], v[184:187]
v_mfma_f32_16x16x32_bf16 v[88:91], v[60:63], v[84:87], 0
v_cvt_pk_bf16_f32 v108, v108, v109
v_cvt_pk_bf16_f32 v109, v110, v111
v_mfma_f32_16x16x32_bf16 v[188:191], a[120:123], a[12:15], v[188:191]
s_waitcnt vmcnt(13) lgkmcnt(10)
ds_write_b64 v16, v[108:109] offset:16192
v_mfma_f32_16x16x32_bf16 v[128:131], a[124:127], a[16:19], v[128:131]
ds_read_b128 a[32:35], v96 offset:256
ds_read_b128 a[36:39], v96 offset:4864
v_mfma_f32_16x16x32_bf16 v[132:135], a[124:127], a[20:23], v[132:135]
buffer_load_dwordx4 a[196:199], v12, s[24:27], s40 offen offset:1024
ds_read_b128 a[40:43], v96 offset:9472
s_waitcnt lgkmcnt(11)
v_mfma_f32_16x16x32_bf16 v[92:95], v[64:67], v[76:79], 0
ds_read_b128 a[44:47], v96 offset:14080
ds_read_b64_tr_b16 v[72:73], v100 offset:6912
v_mfma_f32_16x16x32_bf16 v[136:139], a[124:127], a[24:27], v[136:139]
ds_read_b64_tr_b16 v[74:75], v101 offset:9216
v_cvt_pk_bf16_f32 v88, v88, v89
v_mfma_f32_16x16x32_bf16 v[140:143], a[124:127], a[28:31], v[140:143]
v_cvt_pk_bf16_f32 v89, v90, v91
v_mfma_f32_16x16x32_bf16 v[156:159], a[128:131], a[28:31], v[156:159]
buffer_load_dwordx4 a[200:203], v12, s[24:27], s40 offen offset:2048
v_mfma_f32_16x16x32_bf16 v[104:107], v[64:67], v[80:83], 0
ds_write_b64 v16, v[88:89] offset:18496
v_mfma_f32_16x16x32_bf16 v[152:155], a[128:131], a[24:27], v[152:155]
v_cvt_pk_bf16_f32 v92, v92, v93
v_cvt_pk_bf16_f32 v93, v94, v95
v_mfma_f32_16x16x32_bf16 v[148:151], a[128:131], a[20:23], v[148:151]
ds_write_b64 v16, v[92:93] offset:13920
v_mfma_f32_16x16x32_bf16 v[144:147], a[128:131], a[16:19], v[144:147]
v_mfma_f32_16x16x32_bf16 v[108:111], v[64:67], v[84:87], 0
buffer_load_dwordx4 a[204:207], v12, s[24:27], s40 offen offset:3072
v_cvt_pk_bf16_f32 v104, v104, v105
v_mfma_f32_16x16x32_bf16 v[112:115], a[132:135], a[16:19], v[112:115]
v_cvt_pk_bf16_f32 v105, v106, v107
v_mfma_f32_16x16x32_bf16 v[116:119], a[132:135], a[20:23], v[116:119]
ds_write_b64 v16, v[104:105] offset:16224
v_mfma_f32_16x16x32_bf16 v[120:123], a[132:135], a[24:27], v[120:123]
s_waitcnt lgkmcnt(12)
v_mfma_f32_16x16x32_bf16 v[88:91], v[68:71], v[76:79], 0
buffer_load_dwordx4 a[208:211], v13, s[24:27], s40 offen offset:0
v_cvt_pk_bf16_f32 v108, v108, v109
v_mfma_f32_16x16x32_bf16 v[124:127], a[132:135], a[28:31], v[124:127]
v_cvt_pk_bf16_f32 v109, v110, v111
v_mfma_f32_16x16x32_bf16 v[172:175], a[136:139], a[28:31], v[172:175]
ds_write_b64 v16, v[108:109] offset:18528
v_mfma_f32_16x16x32_bf16 v[168:171], a[136:139], a[24:27], v[168:171]
v_mfma_f32_16x16x32_bf16 v[92:95], v[68:71], v[80:83], 0
v_cvt_pk_bf16_f32 v88, v88, v89
v_cvt_pk_bf16_f32 v89, v90, v91
v_mfma_f32_16x16x32_bf16 v[164:167], a[136:139], a[20:23], v[164:167]
buffer_load_dwordx4 a[212:215], v13, s[24:27], s40 offen offset:1024
v_mfma_f32_16x16x32_bf16 v[160:163], a[136:139], a[16:19], v[160:163]
ds_write_b64 v17, v[88:89] offset:0
v_mfma_f32_16x16x32_bf16 v[176:179], a[140:143], a[16:19], v[176:179]
v_mfma_f32_16x16x32_bf16 v[104:107], v[68:71], v[84:87], 0
v_cvt_pk_bf16_f32 v92, v92, v93
v_cvt_pk_bf16_f32 v93, v94, v95
v_mfma_f32_16x16x32_bf16 v[180:183], a[140:143], a[20:23], v[180:183]
buffer_load_dwordx4 a[216:219], v13, s[24:27], s40 offen offset:2048
v_mfma_f32_16x16x32_bf16 v[184:187], a[140:143], a[24:27], v[184:187]
ds_write_b64 v17, v[92:93] offset:2304
v_mfma_f32_16x16x32_bf16 v[188:191], a[140:143], a[28:31], v[188:191]
s_waitcnt vmcnt(14) lgkmcnt(8)
v_mfma_f32_16x16x32_bf16 v[128:131], a[144:147], a[32:35], v[128:131]
ds_read_b128 a[48:51], v97 offset:128
ds_read_b128 a[52:55], v97 offset:4736
s_waitcnt lgkmcnt(8)
v_mfma_f32_16x16x32_bf16 v[108:111], v[72:75], v[76:79], 0
buffer_load_dwordx4 a[220:223], v13, s[24:27], s40 offen offset:3072
ds_read_b128 a[56:59], v97 offset:9344
v_mfma_f32_16x16x32_bf16 v[132:135], a[144:147], a[36:39], v[132:135]
ds_read_b128 a[60:63], v97 offset:13952
v_cvt_pk_bf16_f32 v104, v104, v105
v_mfma_f32_16x16x32_bf16 v[136:139], a[144:147], a[40:43], v[136:139]
v_cvt_pk_bf16_f32 v105, v106, v107
v_mfma_f32_16x16x32_bf16 v[140:143], a[144:147], a[44:47], v[140:143]
ds_write_b64 v17, v[104:105] offset:4608
v_mfma_f32_16x16x32_bf16 v[88:91], v[72:75], v[80:83], 0
v_cvt_pk_bf16_f32 v108, v108, v109
v_cvt_pk_bf16_f32 v109, v110, v111
v_mfma_f32_16x16x32_bf16 v[156:159], a[148:151], a[44:47], v[156:159]
buffer_load_dwordx4 a[224:227], v14, s[24:27], s40 offen offset:0
v_mfma_f32_16x16x32_bf16 v[152:155], a[148:151], a[40:43], v[152:155]
ds_write_b64 v17, v[108:109] offset:6912
v_mfma_f32_16x16x32_bf16 v[148:151], a[148:151], a[36:39], v[148:151]
v_mfma_f32_16x16x32_bf16 v[92:95], v[72:75], v[84:87], 0
s_add_u32 s84, s84, 3072
buffer_load_dwordx4 v[76:79], v12, s[24:27], s84 offen offset:0
buffer_load_dwordx4 v[80:83], v12, s[24:27], s84 offen offset:1024
v_mfma_f32_16x16x32_bf16 v[144:147], a[148:151], a[32:35], v[144:147]
buffer_load_dwordx4 a[228:231], v14, s[24:27], s40 offen offset:1024
buffer_load_dwordx4 v[84:87], v12, s[24:27], s84 offen offset:2048
v_mfma_f32_16x16x32_bf16 v[112:115], a[152:155], a[32:35], v[112:115]
v_cvt_pk_bf16_f32 v88, v88, v89
v_cvt_pk_bf16_f32 v89, v90, v91
v_mfma_f32_16x16x32_bf16 v[116:119], a[152:155], a[36:39], v[116:119]
ds_write_b64 v17, v[88:89] offset:9216
v_mfma_f32_16x16x32_bf16 v[120:123], a[152:155], a[40:43], v[120:123]
v_cvt_pk_bf16_f32 v92, v92, v93
v_cvt_pk_bf16_f32 v93, v94, v95
v_mfma_f32_16x16x32_bf16 v[124:127], a[152:155], a[44:47], v[124:127]
ds_write_b64 v17, v[92:93] offset:11520
v_mfma_f32_16x16x32_bf16 v[172:175], a[156:159], a[44:47], v[172:175]
buffer_load_dwordx4 a[232:235], v14, s[24:27], s40 offen offset:2048
v_mfma_f32_16x16x32_bf16 v[168:171], a[156:159], a[40:43], v[168:171]
v_mfma_f32_16x16x32_bf16 v[164:167], a[156:159], a[36:39], v[164:167]
v_mfma_f32_16x16x32_bf16 v[160:163], a[156:159], a[32:35], v[160:163]
v_mfma_f32_16x16x32_bf16 v[176:179], a[160:163], a[32:35], v[176:179]
buffer_load_dwordx4 a[236:239], v14, s[24:27], s40 offen offset:3072
v_mfma_f32_16x16x32_bf16 v[180:183], a[160:163], a[36:39], v[180:183]
v_mfma_f32_16x16x32_bf16 v[184:187], a[160:163], a[40:43], v[184:187]
v_mfma_f32_16x16x32_bf16 v[188:191], a[160:163], a[44:47], v[188:191]
s_waitcnt lgkmcnt(4)
v_mfma_f32_16x16x32_bf16 v[192:195], a[104:107], a[48:51], v[192:195]
ds_read_b128 a[0:3], v97 offset:192
ds_read_b128 a[4:7], v97 offset:4800
v_mfma_f32_16x16x32_bf16 v[196:199], a[104:107], a[52:55], v[196:199]
buffer_load_dwordx4 a[240:243], v15, s[24:27], s40 offen offset:0
ds_read_b128 a[8:11], v97 offset:9408
v_mfma_f32_16x16x32_bf16 v[200:203], a[104:107], a[56:59], v[200:203]
ds_read_b128 a[12:15], v97 offset:14016
v_mfma_f32_16x16x32_bf16 v[204:207], a[104:107], a[60:63], v[204:207]
v_fmac_f32 v192, s4, v128
v_fmac_f32_e64 v193, s4, v129
v_mfma_f32_16x16x32_bf16 v[220:223], a[108:111], a[60:63], v[220:223]
v_fmac_f32 v194, s4, v130
v_fmac_f32 v195, s4, v131
v_mfma_f32_16x16x32_bf16 v[216:219], a[108:111], a[56:59], v[216:219]
buffer_load_dwordx4 a[244:247], v15, s[24:27], s40 offen offset:1024
v_fmac_f32_e64 v196, s4, v132
v_mfma_f32_16x16x32_bf16 v[212:215], a[108:111], a[52:55], v[212:215]
v_fmac_f32 v197, s4, v133
v_fmac_f32 v198, s4, v134
v_mfma_f32_16x16x32_bf16 v[208:211], a[108:111], a[48:51], v[208:211]
v_fmac_f32 v199, s4, v135
v_fmac_f32 v200, s4, v136
v_mfma_f32_16x16x32_bf16 v[224:227], a[116:119], a[48:51], v[224:227]
v_fmac_f32 v201, s4, v137
v_fmac_f32 v202, s4, v138
v_mfma_f32_16x16x32_bf16 v[228:231], a[116:119], a[52:55], v[228:231]
v_fmac_f32 v203, s4, v139
v_fmac_f32 v204, s4, v140
v_mfma_f32_16x16x32_bf16 v[232:235], a[116:119], a[56:59], v[232:235]
buffer_load_dwordx4 a[248:251], v15, s[24:27], s40 offen offset:2048
v_fmac_f32_e64 v205, s4, v141
v_mfma_f32_16x16x32_bf16 v[236:239], a[116:119], a[60:63], v[236:239]
v_fmac_f32 v206, s4, v142
v_fmac_f32 v207, s4, v143
v_mfma_f32_16x16x32_bf16 v[252:255], a[120:123], a[60:63], v[252:255]
v_fmac_f32 v208, s4, v144
v_fmac_f32 v209, s4, v145
v_mfma_f32_16x16x32_bf16 v[248:251], a[120:123], a[56:59], v[248:251]
v_fmac_f32 v210, s4, v146
v_fmac_f32 v211, s4, v147
v_mfma_f32_16x16x32_bf16 v[244:247], a[120:123], a[52:55], v[244:247]
buffer_load_dwordx4 a[252:255], v15, s[24:27], s40 offen offset:3072
v_fmac_f32_e64 v212, s4, v148
v_mfma_f32_16x16x32_bf16 v[240:243], a[120:123], a[48:51], v[240:243]
s_waitcnt lgkmcnt(0)
v_fmac_f32 v213, s4, v149
v_fmac_f32_e64 v214, s4, v150
v_mfma_f32_16x16x32_bf16 v[192:195], a[124:127], a[0:3], v[192:195]
ds_read_b128 a[16:19], v97 offset:256
ds_read_b128 a[20:23], v97 offset:4864
v_mfma_f32_16x16x32_bf16 v[196:199], a[124:127], a[4:7], v[196:199]
ds_read_b128 a[24:27], v97 offset:9472
ds_read_b128 a[28:31], v97 offset:14080
v_mfma_f32_16x16x32_bf16 v[200:203], a[124:127], a[8:11], v[200:203]
v_fmac_f32 v215, s4, v151
v_fmac_f32 v216, s4, v152
v_mfma_f32_16x16x32_bf16 v[204:207], a[124:127], a[12:15], v[204:207]
s_add_u32 s40, s40, 16384
buffer_load_dwordx4 a[72:75], v12, s[24:27], s40 offen offset:0
v_fmac_f32_e64 v224, s4, v160
v_mfma_f32_16x16x32_bf16 v[220:223], a[128:131], a[12:15], v[220:223]
v_fmac_f32 v225, s4, v161
v_fmac_f32 v226, s4, v162
v_mfma_f32_16x16x32_bf16 v[216:219], a[128:131], a[8:11], v[216:219]
v_fmac_f32 v227, s4, v163
v_fmac_f32 v228, s4, v164
v_mfma_f32_16x16x32_bf16 v[212:215], a[128:131], a[4:7], v[212:215]
v_fmac_f32 v229, s4, v165
v_fmac_f32 v230, s4, v166
v_mfma_f32_16x16x32_bf16 v[208:211], a[128:131], a[0:3], v[208:211]
buffer_load_dwordx4 a[64:67], v12, s[24:27], s40 offen offset:1024
v_fmac_f32_e64 v220, s4, v156
v_mfma_f32_16x16x32_bf16 v[224:227], a[136:139], a[0:3], v[224:227]
v_fmac_f32 v217, s4, v153
v_fmac_f32 v218, s4, v154
v_mfma_f32_16x16x32_bf16 v[228:231], a[136:139], a[4:7], v[228:231]
v_fmac_f32 v219, s4, v155
v_fmac_f32 v221, s4, v157
v_mfma_f32_16x16x32_bf16 v[232:235], a[136:139], a[8:11], v[232:235]
v_fmac_f32 v222, s4, v158
v_fmac_f32 v223, s4, v159
v_mfma_f32_16x16x32_bf16 v[236:239], a[136:139], a[12:15], v[236:239]
v_fmac_f32 v240, s4, v176
v_fmac_f32 v241, s4, v177
v_mfma_f32_16x16x32_bf16 v[252:255], a[140:143], a[12:15], v[252:255]
buffer_load_dwordx4 a[68:71], v12, s[24:27], s40 offen offset:2048
v_fmac_f32_e64 v231, s4, v167
v_mfma_f32_16x16x32_bf16 v[248:251], a[140:143], a[8:11], v[248:251]
v_fmac_f32 v232, s4, v168
v_fmac_f32 v233, s4, v169
v_mfma_f32_16x16x32_bf16 v[244:247], a[140:143], a[4:7], v[244:247]
v_fmac_f32 v234, s4, v170
v_fmac_f32 v235, s4, v171
v_mfma_f32_16x16x32_bf16 v[240:243], a[140:143], a[0:3], v[240:243]
s_waitcnt lgkmcnt(0)
v_fmac_f32 v236, s4, v172
v_fmac_f32_e64 v237, s4, v173
v_mfma_f32_16x16x32_bf16 v[192:195], a[144:147], a[16:19], v[192:195]
buffer_load_dwordx4 a[76:79], v12, s[24:27], s40 offen offset:3072
v_fmac_f32_e64 v238, s4, v174
v_mfma_f32_16x16x32_bf16 v[196:199], a[144:147], a[20:23], v[196:199]
v_fmac_f32 v239, s4, v175
v_fmac_f32 v242, s4, v178
v_mfma_f32_16x16x32_bf16 v[200:203], a[144:147], a[24:27], v[200:203]
s_barrier
v_mfma_f32_16x16x32_bf16 v[204:207], a[144:147], a[28:31], v[204:207]
ds_read_b128 a[32:35], v2 offset:47872
ds_read_b128 a[36:39], v2 offset:52480
v_mfma_f32_16x16x32_bf16 v[220:223], a[148:151], a[28:31], v[220:223]
ds_read_b128 a[40:43], v2 offset:57088
ds_read_b128 a[44:47], v2 offset:61696
v_mfma_f32_16x16x32_bf16 v[216:219], a[148:151], a[24:27], v[216:219]
v_fmac_f32 v243, s4, v179
v_fmac_f32_e64 v244, s4, v180
v_mfma_f32_16x16x32_bf16 v[212:215], a[148:151], a[20:23], v[212:215]
L_isl1:
s_cbranch_execz L_wret
buffer_load_dwordx4 a[80:83], v13, s[24:27], s40 offen offset:0
v_fmac_f32 v245, s4, v181
v_mfma_f32_16x16x32_bf16 v[208:211], a[148:151], a[16:19], v[208:211]
v_fmac_f32 v246, s4, v182
v_fmac_f32 v247, s4, v183
v_mfma_f32_16x16x32_bf16 v[224:227], a[156:159], a[16:19], v[224:227]
v_fmac_f32 v248, s4, v184
v_fmac_f32 v249, s4, v185
v_mfma_f32_16x16x32_bf16 v[228:231], a[156:159], a[20:23], v[228:231]
v_fmac_f32 v250, s4, v186
v_fmac_f32 v251, s4, v187
v_mfma_f32_16x16x32_bf16 v[232:235], a[156:159], a[24:27], v[232:235]
buffer_load_dwordx4 a[92:95], v13, s[24:27], s40 offen offset:1024
v_mfma_f32_16x16x32_bf16 v[236:239], a[156:159], a[28:31], v[236:239]
v_mfma_f32_16x16x32_bf16 v[252:255], a[160:163], a[28:31], v[252:255]
v_mfma_f32_16x16x32_bf16 v[248:251], a[160:163], a[24:27], v[248:251]
v_mfma_f32_16x16x32_bf16 v[244:247], a[160:163], a[20:23], v[244:247]
v_mfma_f32_16x16x32_bf16 v[240:243], a[160:163], a[16:19], v[240:243]
s_waitcnt vmcnt(27) lgkmcnt(0)
buffer_load_dwordx4 a[84:87], v13, s[24:27], s40 offen offset:2048
s_nop 2
v_fmac_f32 v252, s4, v188
v_fmac_f32 v253, s4, v189
v_fmac_f32 v254, s4, v190
v_fmac_f32 v255, s4, v191
v_mfma_f32_16x16x32_bf16 v[128:131], a[164:167], a[32:35], v[128:131]
ds_read_b128 a[48:51], v2 offset:47936
ds_read_b128 a[52:55], v2 offset:52544
v_mfma_f32_16x16x32_bf16 v[132:135], a[164:167], a[36:39], v[132:135]
ds_read_b128 a[56:59], v2 offset:57152
ds_read_b128 a[60:63], v2 offset:61760
v_mfma_f32_16x16x32_bf16 v[136:139], a[164:167], a[40:43], v[136:139]
v_fmac_f32 v144, s5, v208
v_fmac_f32 v145, s5, v209
v_mfma_f32_16x16x32_bf16 v[140:143], a[164:167], a[44:47], v[140:143]
buffer_load_dwordx4 a[88:91], v13, s[24:27], s40 offen offset:3072
v_fmac_f32_e64 v128, s5, v192
v_mfma_f32_16x16x32_bf16 v[156:159], a[168:171], a[44:47], v[156:159]
v_fmac_f32 v129, s5, v193
v_fmac_f32 v130, s5, v194
v_mfma_f32_16x16x32_bf16 v[152:155], a[168:171], a[40:43], v[152:155]
v_fmac_f32 v131, s5, v195
v_fmac_f32 v132, s5, v196
v_mfma_f32_16x16x32_bf16 v[148:151], a[168:171], a[36:39], v[148:151]
v_fmac_f32 v133, s5, v197
v_fmac_f32 v134, s5, v198
v_mfma_f32_16x16x32_bf16 v[144:147], a[168:171], a[32:35], v[144:147]
buffer_load_dwordx4 a[96:99], v14, s[24:27], s40 offen offset:0
v_fmac_f32_e64 v135, s5, v199
v_mfma_f32_16x16x32_bf16 v[96:99], a[172:175], a[32:35], 0
v_fmac_f32 v136, s5, v200
v_fmac_f32 v137, s5, v201
v_mfma_f32_16x16x32_bf16 v[100:103], a[172:175], a[36:39], 0
v_fmac_f32 v138, s5, v202
v_fmac_f32 v139, s5, v203
v_mfma_f32_16x16x32_bf16 v[104:107], a[172:175], a[40:43], 0
v_fmac_f32 v140, s5, v204
v_fmac_f32 v141, s5, v205
v_mfma_f32_16x16x32_bf16 v[108:111], a[172:175], a[44:47], 0
v_fmac_f32 v142, s5, v206
v_fmac_f32 v143, s5, v207
v_mfma_f32_16x16x32_bf16 v[172:175], a[176:179], a[44:47], v[172:175]
buffer_load_dwordx4 a[100:103], v14, s[24:27], s40 offen offset:1024
v_fmac_f32_e64 v146, s5, v210
v_mfma_f32_16x16x32_bf16 v[168:171], a[176:179], a[40:43], v[168:171]
v_fmac_f32 v147, s5, v211
v_fmac_f32 v148, s5, v212
v_mfma_f32_16x16x32_bf16 v[164:167], a[176:179], a[36:39], v[164:167]
v_fmac_f32 v149, s5, v213
v_fmac_f32 v150, s5, v214
v_mfma_f32_16x16x32_bf16 v[160:163], a[176:179], a[32:35], v[160:163]
v_fmac_f32 v151, s5, v215
v_fmac_f32 v152, s5, v216
v_mfma_f32_16x16x32_bf16 v[176:179], a[180:183], a[32:35], v[176:179]
buffer_load_dwordx4 a[112:115], v14, s[24:27], s40 offen offset:2048
v_fmac_f32_e64 v153, s5, v217
v_mfma_f32_16x16x32_bf16 v[180:183], a[180:183], a[36:39], v[180:183]
v_fmac_f32 v154, s5, v218
v_fmac_f32 v155, s5, v219
v_mfma_f32_16x16x32_bf16 v[184:187], a[180:183], a[40:43], v[184:187]
v_fmac_f32 v156, s5, v220
v_fmac_f32 v157, s5, v221
v_mfma_f32_16x16x32_bf16 v[188:191], a[180:183], a[44:47], v[188:191]
s_waitcnt vmcnt(27) lgkmcnt(0)
v_fmac_f32 v158, s5, v222
v_fmac_f32_e64 v159, s5, v223
v_mfma_f32_16x16x32_bf16 v[128:131], a[184:187], a[48:51], v[128:131]
ds_read_b128 a[0:3], v2 offset:48000
ds_read_b128 a[4:7], v2 offset:52608
v_mfma_f32_16x16x32_bf16 v[132:135], a[184:187], a[52:55], v[132:135]
buffer_load_dwordx4 a[132:135], v14, s[24:27], s40 offen offset:3072
ds_read_b128 a[8:11], v2 offset:57216
v_mfma_f32_16x16x32_bf16 v[136:139], a[184:187], a[56:59], v[136:139]
ds_read_b128 a[12:15], v2 offset:61824
v_fmac_f32_e64 v160, s5, v224
v_mfma_f32_16x16x32_bf16 v[140:143], a[184:187], a[60:63], v[140:143]
v_fmac_f32 v161, s5, v225
v_fmac_f32 v162, s5, v226
v_mfma_f32_16x16x32_bf16 v[156:159], a[188:191], a[60:63], v[156:159]
v_fmac_f32 v163, s5, v227
v_fmac_f32 v164, s5, v228
v_mfma_f32_16x16x32_bf16 v[152:155], a[188:191], a[56:59], v[152:155]
buffer_load_dwordx4 a[152:155], v15, s[24:27], s40 offen offset:0
v_fmac_f32_e64 v165, s5, v229
v_mfma_f32_16x16x32_bf16 v[148:151], a[188:191], a[52:55], v[148:151]
v_fmac_f32 v166, s5, v230
v_fmac_f32 v167, s5, v231
v_mfma_f32_16x16x32_bf16 v[144:147], a[188:191], a[48:51], v[144:147]
v_fmac_f32 v168, s5, v232
v_fmac_f32 v169, s5, v233
v_mfma_f32_16x16x32_bf16 v[96:99], a[192:195], a[48:51], v[96:99]
v_fmac_f32 v170, s5, v234
v_fmac_f32 v171, s5, v235
v_mfma_f32_16x16x32_bf16 v[100:103], a[192:195], a[52:55], v[100:103]
buffer_load_dwordx4 a[104:107], v15, s[24:27], s40 offen offset:1024
v_fmac_f32_e64 v172, s5, v236
v_mfma_f32_16x16x32_bf16 v[104:107], a[192:195], a[56:59], v[104:107]
v_fmac_f32 v176, s5, v240
v_fmac_f32 v177, s5, v241
v_mfma_f32_16x16x32_bf16 v[108:111], a[192:195], a[60:63], v[108:111]
v_fmac_f32 v178, s5, v242
v_fmac_f32 v179, s5, v243
v_mfma_f32_16x16x32_bf16 v[172:175], a[196:199], a[60:63], v[172:175]
v_fmac_f32 v180, s5, v244
v_fmac_f32 v181, s5, v245
v_mfma_f32_16x16x32_bf16 v[168:171], a[196:199], a[56:59], v[168:171]
v_fmac_f32 v182, s5, v246
v_fmac_f32 v183, s5, v247
v_mfma_f32_16x16x32_bf16 v[164:167], a[196:199], a[52:55], v[164:167]
buffer_load_dwordx4 a[108:111], v15, s[24:27], s40 offen offset:2048
v_fmac_f32_e64 v184, s5, v248
v_mfma_f32_16x16x32_bf16 v[160:163], a[196:199], a[48:51], v[160:163]
v_fmac_f32 v173, s5, v237
v_fmac_f32 v174, s5, v238
v_mfma_f32_16x16x32_bf16 v[176:179], a[200:203], a[48:51], v[176:179]
v_fmac_f32 v175, s5, v239
v_fmac_f32 v188, s5, v252
v_mfma_f32_16x16x32_bf16 v[180:183], a[200:203], a[52:55], v[180:183]
v_mul_f32 v208, s78, v208
v_mul_f32 v209, s78, v209
v_mfma_f32_16x16x32_bf16 v[184:187], a[200:203], a[56:59], v[184:187]
buffer_load_dwordx4 a[116:119], v15, s[24:27], s40 offen offset:3072
v_mul_f32_e64 v192, s78, v192
v_mfma_f32_16x16x32_bf16 v[188:191], a[200:203], a[60:63], v[188:191]
s_waitcnt vmcnt(27) lgkmcnt(0)
v_mul_f32 v193, s78, v193
v_mul_f32_e64 v194, s78, v194
v_mfma_f32_16x16x32_bf16 v[128:131], a[204:207], a[0:3], v[128:131]
ds_read_b128 a[16:19], v2 offset:48064
ds_read_b128 a[20:23], v2 offset:52672
v_mfma_f32_16x16x32_bf16 v[132:135], a[204:207], a[4:7], v[132:135]
ds_read_b128 a[24:27], v2 offset:57280
ds_read_b128 a[28:31], v2 offset:61888
v_mfma_f32_16x16x32_bf16 v[136:139], a[204:207], a[8:11], v[136:139]
v_fmac_f32 v185, s5, v249
v_fmac_f32 v186, s5, v250
v_mfma_f32_16x16x32_bf16 v[140:143], a[204:207], a[12:15], v[140:143]
s_add_u32 s40, s40, 16384
buffer_load_dwordx4 a[120:123], v12, s[24:27], s40 offen offset:0
v_fmac_f32_e64 v187, s5, v251
v_mfma_f32_16x16x32_bf16 v[156:159], a[208:211], a[12:15], v[156:159]
v_fmac_f32 v189, s5, v253
v_fmac_f32 v190, s5, v254
v_mfma_f32_16x16x32_bf16 v[152:155], a[208:211], a[8:11], v[152:155]
v_fmac_f32 v191, s5, v255
v_mul_f32 v195, s78, v195
v_mfma_f32_16x16x32_bf16 v[148:151], a[208:211], a[4:7], v[148:151]
v_mul_f32 v196, s78, v196
v_mul_f32 v197, s78, v197
v_mfma_f32_16x16x32_bf16 v[144:147], a[208:211], a[0:3], v[144:147]
buffer_load_dwordx4 a[124:127], v12, s[24:27], s40 offen offset:1024
v_mul_f32_e64 v198, s78, v198
v_mfma_f32_16x16x32_bf16 v[96:99], a[212:215], a[0:3], v[96:99]
v_mul_f32 v199, s78, v199
v_mul_f32 v200, s78, v200
v_mfma_f32_16x16x32_bf16 v[100:103], a[212:215], a[4:7], v[100:103]
v_mul_f32 v201, s78, v201
v_mul_f32 v202, s78, v202
v_mfma_f32_16x16x32_bf16 v[104:107], a[212:215], a[8:11], v[104:107]
v_mul_f32 v203, s78, v203
v_mul_f32 v204, s78, v204
v_mfma_f32_16x16x32_bf16 v[108:111], a[212:215], a[12:15], v[108:111]
v_fmac_f32 v96, s79, v112
v_fmac_f32 v97, s79, v113
v_mfma_f32_16x16x32_bf16 v[172:175], a[216:219], a[12:15], v[172:175]
buffer_load_dwordx4 a[128:131], v12, s[24:27], s40 offen offset:2048
v_fmac_f32_e64 v98, s79, v114
v_mfma_f32_16x16x32_bf16 v[168:171], a[216:219], a[8:11], v[168:171]
v_fmac_f32 v99, s79, v115
v_fmac_f32 v100, s79, v116
v_mfma_f32_16x16x32_bf16 v[164:167], a[216:219], a[4:7], v[164:167]
v_fmac_f32 v101, s79, v117
v_fmac_f32 v102, s79, v118
v_mfma_f32_16x16x32_bf16 v[160:163], a[216:219], a[0:3], v[160:163]
v_fmac_f32 v103, s79, v119
v_fmac_f32 v104, s79, v120
v_mfma_f32_16x16x32_bf16 v[176:179], a[220:223], a[0:3], v[176:179]
buffer_load_dwordx4 a[136:139], v12, s[24:27], s40 offen offset:3072
v_fmac_f32_e64 v105, s79, v121
v_mfma_f32_16x16x32_bf16 v[180:183], a[220:223], a[4:7], v[180:183]
v_fmac_f32 v106, s79, v122
v_fmac_f32 v107, s79, v123
v_mfma_f32_16x16x32_bf16 v[184:187], a[220:223], a[8:11], v[184:187]
v_mul_f32 v205, s78, v205
v_fmac_f32 v108, s79, v124
v_mfma_f32_16x16x32_bf16 v[188:191], a[220:223], a[12:15], v[188:191]
s_waitcnt vmcnt(23) lgkmcnt(0)
v_fmac_f32 v109, s79, v125
v_fmac_f32_e64 v110, s79, v126
v_mfma_f32_16x16x32_bf16 v[128:131], a[224:227], a[16:19], v[128:131]
buffer_load_dwordx4 a[140:143], v13, s[24:27], s40 offen offset:0
ds_read_b128 a[32:35], v3 offset:45600
v_mfma_f32_16x16x32_bf16 v[132:135], a[224:227], a[20:23], v[132:135]
ds_read_b128 a[36:39], v3 offset:50208
ds_read_b128 a[40:43], v3 offset:54816
v_mfma_f32_16x16x32_bf16 v[136:139], a[224:227], a[24:27], v[136:139]
ds_read_b128 a[44:47], v3 offset:59424
v_fmac_f32_e64 v111, s79, v127
v_mfma_f32_16x16x32_bf16 v[140:143], a[224:227], a[28:31], v[140:143]
v_mul_f32 v206, s78, v206
v_mul_f32 v207, s78, v207
v_mfma_f32_16x16x32_bf16 v[156:159], a[228:231], a[28:31], v[156:159]
v_mul_f32 v210, s78, v210
v_mul_f32 v211, s78, v211
v_mfma_f32_16x16x32_bf16 v[152:155], a[228:231], a[24:27], v[152:155]
buffer_load_dwordx4 a[144:147], v13, s[24:27], s40 offen offset:1024
v_mul_f32_e64 v212, s78, v212
v_mfma_f32_16x16x32_bf16 v[148:151], a[228:231], a[20:23], v[148:151]
v_mul_f32 v213, s78, v213
v_mul_f32 v214, s78, v214
v_mfma_f32_16x16x32_bf16 v[144:147], a[228:231], a[16:19], v[144:147]
v_mul_f32 v215, s78, v215
v_mul_f32 v216, s78, v216
v_mfma_f32_16x16x32_bf16 v[96:99], a[232:235], a[16:19], v[96:99]
v_mul_f32 v217, s78, v217
v_mul_f32 v218, s78, v218
v_mfma_f32_16x16x32_bf16 v[100:103], a[232:235], a[20:23], v[100:103]
buffer_load_dwordx4 a[148:151], v13, s[24:27], s40 offen offset:2048
v_mul_f32_e64 v219, s78, v219
v_mfma_f32_16x16x32_bf16 v[104:107], a[232:235], a[24:27], v[104:107]
v_mul_f32 v220, s78, v220
v_mul_f32 v221, s78, v221
v_mfma_f32_16x16x32_bf16 v[108:111], a[232:235], a[28:31], v[108:111]
v_mul_f32 v222, s78, v222
v_mul_f32 v223, s78, v223
v_mfma_f32_16x16x32_bf16 v[172:175], a[236:239], a[28:31], v[172:175]
v_mul_f32 v224, s78, v224
v_mul_f32 v225, s78, v225
v_mfma_f32_16x16x32_bf16 v[168:171], a[236:239], a[24:27], v[168:171]
v_mul_f32 v226, s78, v226
v_mul_f32 v227, s78, v227
v_mfma_f32_16x16x32_bf16 v[164:167], a[236:239], a[20:23], v[164:167]
buffer_load_dwordx4 a[156:159], v13, s[24:27], s40 offen offset:3072
v_mul_f32_e64 v228, s78, v228
v_mfma_f32_16x16x32_bf16 v[160:163], a[236:239], a[16:19], v[160:163]
v_mul_f32 v229, s78, v229
v_mul_f32 v230, s78, v230
v_mfma_f32_16x16x32_bf16 v[176:179], a[240:243], a[16:19], v[176:179]
v_mul_f32 v231, s78, v231
v_mul_f32 v232, s78, v232
v_mfma_f32_16x16x32_bf16 v[180:183], a[240:243], a[20:23], v[180:183]
v_mul_f32 v233, s78, v233
v_mul_f32 v234, s78, v234
v_mfma_f32_16x16x32_bf16 v[184:187], a[240:243], a[24:27], v[184:187]
buffer_load_dwordx4 a[160:163], v14, s[24:27], s40 offen offset:0
v_mul_f32_e64 v235, s78, v235
v_mfma_f32_16x16x32_bf16 v[188:191], a[240:243], a[28:31], v[188:191]
s_waitcnt vmcnt(23) lgkmcnt(0)
v_mul_f32 v236, s78, v236
v_mul_f32_e64 v240, s78, v240
v_mfma_f32_16x16x32_bf16 v[128:131], a[244:247], a[32:35], v[128:131]
ds_read_b128 a[48:51], v2 offset:45600
ds_read_b128 a[52:55], v2 offset:50208
v_mfma_f32_16x16x32_bf16 v[132:135], a[244:247], a[36:39], v[132:135]
ds_read_b128 a[56:59], v2 offset:54816
ds_read_b128 a[60:63], v2 offset:59424
v_mfma_f32_16x16x32_bf16 v[136:139], a[244:247], a[40:43], v[136:139]
buffer_load_dwordx4 a[164:167], v14, s[24:27], s40 offen offset:1024
v_mul_f32_e64 v241, s78, v241
v_mfma_f32_16x16x32_bf16 v[140:143], a[244:247], a[44:47], v[140:143]
v_mul_f32 v242, s78, v242
v_mul_f32 v243, s78, v243
v_mfma_f32_16x16x32_bf16 v[156:159], a[248:251], a[44:47], v[156:159]
v_mul_f32 v244, s78, v244
v_mul_f32 v245, s78, v245
v_mfma_f32_16x16x32_bf16 v[152:155], a[248:251], a[40:43], v[152:155]
v_mul_f32 v246, s78, v246
v_mul_f32 v247, s78, v247
v_mfma_f32_16x16x32_bf16 v[148:151], a[248:251], a[36:39], v[148:151]
v_mul_f32 v248, s78, v248
v_mul_f32 v237, s78, v237
v_mfma_f32_16x16x32_bf16 v[144:147], a[248:251], a[32:35], v[144:147]
buffer_load_dwordx4 a[168:171], v14, s[24:27], s40 offen offset:2048
v_mul_f32_e64 v238, s78, v238
v_mfma_f32_16x16x32_bf16 v[96:99], a[252:255], a[32:35], v[96:99]
v_mul_f32 v239, s78, v239
v_mul_f32 v252, s78, v252
v_mfma_f32_16x16x32_bf16 v[100:103], a[252:255], a[36:39], v[100:103]
v_mul_f32 v249, s78, v249
v_mul_f32 v250, s78, v250
v_mfma_f32_16x16x32_bf16 v[104:107], a[252:255], a[40:43], v[104:107]
v_mul_f32 v251, s78, v251
v_mul_f32 v253, s78, v253
v_mfma_f32_16x16x32_bf16 v[108:111], a[252:255], a[44:47], v[108:111]
buffer_load_dwordx4 a[172:175], v14, s[24:27], s40 offen offset:3072
v_mul_f32_e64 v254, s78, v254
v_mfma_f32_16x16x32_bf16 v[172:175], a[72:75], a[44:47], v[172:175]
v_mul_f32_e64 v255, s78, v255
v_mfma_f32_16x16x32_bf16 v[168:171], a[72:75], a[40:43], v[168:171]
v_mfma_f32_16x16x32_bf16 v[164:167], a[72:75], a[36:39], v[164:167]
v_mfma_f32_16x16x32_bf16 v[160:163], a[72:75], a[32:35], v[160:163]
v_mfma_f32_16x16x32_bf16 v[176:179], a[64:67], a[32:35], v[176:179]
buffer_load_dwordx4 a[176:179], v15, s[24:27], s40 offen offset:0
v_mfma_f32_16x16x32_bf16 v[180:183], a[64:67], a[36:39], v[180:183]
v_mfma_f32_16x16x32_bf16 v[184:187], a[64:67], a[40:43], v[184:187]
v_mfma_f32_16x16x32_bf16 v[188:191], a[64:67], a[44:47], v[188:191]
s_waitcnt vmcnt(22) lgkmcnt(0)
v_mfma_f32_16x16x32_bf16 v[128:131], a[68:71], a[48:51], v[128:131]
buffer_load_dwordx4 a[180:183], v15, s[24:27], s40 offen offset:1024
ds_read_b128 a[0:3], v2 offset:45664
v_mfma_f32_16x16x32_bf16 v[132:135], a[68:71], a[52:55], v[132:135]
ds_read_b128 a[4:7], v2 offset:50272
ds_read_b128 a[8:11], v2 offset:54880
v_mfma_f32_16x16x32_bf16 v[136:139], a[68:71], a[56:59], v[136:139]
ds_read_b128 a[12:15], v2 offset:59488
v_mfma_f32_16x16x32_bf16 v[140:143], a[68:71], a[60:63], v[140:143]
v_mfma_f32_16x16x32_bf16 v[156:159], a[76:79], a[60:63], v[156:159]
buffer_load_dwordx4 a[184:187], v15, s[24:27], s40 offen offset:2048
v_mfma_f32_16x16x32_bf16 v[152:155], a[76:79], a[56:59], v[152:155]
v_mfma_f32_16x16x32_bf16 v[148:151], a[76:79], a[52:55], v[148:151]
v_mfma_f32_16x16x32_bf16 v[144:147], a[76:79], a[48:51], v[144:147]
v_mfma_f32_16x16x32_bf16 v[96:99], a[80:83], a[48:51], v[96:99]
v_mfma_f32_16x16x32_bf16 v[100:103], a[80:83], a[52:55], v[100:103]
buffer_load_dwordx4 a[188:191], v15, s[24:27], s40 offen offset:3072
v_mfma_f32_16x16x32_bf16 v[104:107], a[80:83], a[56:59], v[104:107]
v_mfma_f32_16x16x32_bf16 v[108:111], a[80:83], a[60:63], v[108:111]
v_mfma_f32_16x16x32_bf16 v[172:175], a[92:95], a[60:63], v[172:175]
v_mfma_f32_16x16x32_bf16 v[168:171], a[92:95], a[56:59], v[168:171]
s_add_u32 s40, s40, 16384
buffer_load_dwordx4 a[192:195], v12, s[24:27], s40 offen offset:0
v_mfma_f32_16x16x32_bf16 v[164:167], a[92:95], a[52:55], v[164:167]
v_mfma_f32_16x16x32_bf16 v[160:163], a[92:95], a[48:51], v[160:163]
v_mfma_f32_16x16x32_bf16 v[176:179], a[84:87], a[48:51], v[176:179]
v_mfma_f32_16x16x32_bf16 v[180:183], a[84:87], a[52:55], v[180:183]
v_mfma_f32_16x16x32_bf16 v[184:187], a[84:87], a[56:59], v[184:187]
buffer_load_dwordx4 a[196:199], v12, s[24:27], s40 offen offset:1024
v_mfma_f32_16x16x32_bf16 v[188:191], a[84:87], a[60:63], v[188:191]
s_waitcnt vmcnt(22) lgkmcnt(0)
v_mfma_f32_16x16x32_bf16 v[128:131], a[88:91], a[0:3], v[128:131]
ds_read_b128 a[16:19], v2 offset:45728
ds_read_b128 a[20:23], v2 offset:50336
v_mfma_f32_16x16x32_bf16 v[132:135], a[88:91], a[4:7], v[132:135]
ds_read_b128 a[24:27], v2 offset:54944
ds_read_b128 a[28:31], v2 offset:59552
v_mfma_f32_16x16x32_bf16 v[136:139], a[88:91], a[8:11], v[136:139]
buffer_load_dwordx4 a[200:203], v12, s[24:27], s40 offen offset:2048
v_mfma_f32_16x16x32_bf16 v[140:143], a[88:91], a[12:15], v[140:143]
v_mfma_f32_16x16x32_bf16 v[156:159], a[96:99], a[12:15], v[156:159]
v_mfma_f32_16x16x32_bf16 v[152:155], a[96:99], a[8:11], v[152:155]
v_mfma_f32_16x16x32_bf16 v[148:151], a[96:99], a[4:7], v[148:151]
v_mfma_f32_16x16x32_bf16 v[144:147], a[96:99], a[0:3], v[144:147]
buffer_load_dwordx4 a[204:207], v12, s[24:27], s40 offen offset:3072
v_mfma_f32_16x16x32_bf16 v[96:99], a[100:103], a[0:3], v[96:99]
v_mfma_f32_16x16x32_bf16 v[100:103], a[100:103], a[4:7], v[100:103]
v_mfma_f32_16x16x32_bf16 v[104:107], a[100:103], a[8:11], v[104:107]
v_mfma_f32_16x16x32_bf16 v[108:111], a[100:103], a[12:15], v[108:111]
buffer_load_dwordx4 a[208:211], v13, s[24:27], s40 offen offset:0
v_mfma_f32_16x16x32_bf16 v[172:175], a[112:115], a[12:15], v[172:175]
v_mfma_f32_16x16x32_bf16 v[168:171], a[112:115], a[8:11], v[168:171]
v_mfma_f32_16x16x32_bf16 v[164:167], a[112:115], a[4:7], v[164:167]
v_mfma_f32_16x16x32_bf16 v[160:163], a[112:115], a[0:3], v[160:163]
buffer_load_dwordx4 a[212:215], v13, s[24:27], s40 offen offset:1024
v_mfma_f32_16x16x32_bf16 v[176:179], a[132:135], a[0:3], v[176:179]
v_mfma_f32_16x16x32_bf16 v[180:183], a[132:135], a[4:7], v[180:183]
v_mfma_f32_16x16x32_bf16 v[184:187], a[132:135], a[8:11], v[184:187]
v_mfma_f32_16x16x32_bf16 v[188:191], a[132:135], a[12:15], v[188:191]
s_waitcnt vmcnt(21) lgkmcnt(0)
v_mfma_f32_16x16x32_bf16 v[128:131], a[152:155], a[16:19], v[128:131]
buffer_load_dwordx4 a[216:219], v13, s[24:27], s40 offen offset:2048
ds_read_b128 a[32:35], v2 offset:45792
v_mfma_f32_16x16x32_bf16 v[132:135], a[152:155], a[20:23], v[132:135]
ds_read_b128 a[36:39], v2 offset:50400
ds_read_b128 a[40:43], v2 offset:55008
v_mfma_f32_16x16x32_bf16 v[136:139], a[152:155], a[24:27], v[136:139]
ds_read_b128 a[44:47], v2 offset:59616
v_mfma_f32_16x16x32_bf16 v[140:143], a[152:155], a[28:31], v[140:143]
v_mfma_f32_16x16x32_bf16 v[156:159], a[104:107], a[28:31], v[156:159]
buffer_load_dwordx4 a[220:223], v13, s[24:27], s40 offen offset:3072
v_mfma_f32_16x16x32_bf16 v[152:155], a[104:107], a[24:27], v[152:155]
v_mfma_f32_16x16x32_bf16 v[148:151], a[104:107], a[20:23], v[148:151]
v_mfma_f32_16x16x32_bf16 v[144:147], a[104:107], a[16:19], v[144:147]
v_mfma_f32_16x16x32_bf16 v[96:99], a[108:111], a[16:19], v[96:99]
v_mfma_f32_16x16x32_bf16 v[100:103], a[108:111], a[20:23], v[100:103]
buffer_load_dwordx4 a[224:227], v14, s[24:27], s40 offen offset:0
v_mfma_f32_16x16x32_bf16 v[104:107], a[108:111], a[24:27], v[104:107]
v_mfma_f32_16x16x32_bf16 v[108:111], a[108:111], a[28:31], v[108:111]
v_mfma_f32_16x16x32_bf16 v[172:175], a[116:119], a[28:31], v[172:175]
v_mfma_f32_16x16x32_bf16 v[168:171], a[116:119], a[24:27], v[168:171]
buffer_load_dwordx4 a[228:231], v14, s[24:27], s40 offen offset:1024
v_mfma_f32_16x16x32_bf16 v[164:167], a[116:119], a[20:23], v[164:167]
v_mfma_f32_16x16x32_bf16 v[160:163], a[116:119], a[16:19], v[160:163]
v_mfma_f32_16x16x32_bf16 v[176:179], a[120:123], a[16:19], v[176:179]
v_mfma_f32_16x16x32_bf16 v[180:183], a[120:123], a[20:23], v[180:183]
buffer_load_dwordx4 a[232:235], v14, s[24:27], s40 offen offset:2048
v_mfma_f32_16x16x32_bf16 v[184:187], a[120:123], a[24:27], v[184:187]
v_mfma_f32_16x16x32_bf16 v[188:191], a[120:123], a[28:31], v[188:191]
s_waitcnt vmcnt(21) lgkmcnt(0)
v_mfma_f32_16x16x32_bf16 v[128:131], a[124:127], a[32:35], v[128:131]
ds_read_b128 a[48:51], v4 offset:47872
ds_read_b128 a[52:55], v4 offset:52480
v_mfma_f32_16x16x32_bf16 v[132:135], a[124:127], a[36:39], v[132:135]
ds_read_b128 a[56:59], v4 offset:57088
ds_read_b128 a[60:63], v4 offset:61696
v_mfma_f32_16x16x32_bf16 v[136:139], a[124:127], a[40:43], v[136:139]
buffer_load_dwordx4 a[236:239], v14, s[24:27], s40 offen offset:3072
v_mfma_f32_16x16x32_bf16 v[140:143], a[124:127], a[44:47], v[140:143]
v_mfma_f32_16x16x32_bf16 v[156:159], a[128:131], a[44:47], v[156:159]
v_mfma_f32_16x16x32_bf16 v[152:155], a[128:131], a[40:43], v[152:155]
v_mfma_f32_16x16x32_bf16 v[148:151], a[128:131], a[36:39], v[148:151]
buffer_load_dwordx4 a[240:243], v15, s[24:27], s40 offen offset:0
v_mfma_f32_16x16x32_bf16 v[144:147], a[128:131], a[32:35], v[144:147]
v_mfma_f32_16x16x32_bf16 v[96:99], a[136:139], a[32:35], v[96:99]
v_mfma_f32_16x16x32_bf16 v[100:103], a[136:139], a[36:39], v[100:103]
v_mfma_f32_16x16x32_bf16 v[104:107], a[136:139], a[40:43], v[104:107]
v_mfma_f32_16x16x32_bf16 v[108:111], a[136:139], a[44:47], v[108:111]
buffer_load_dwordx4 a[244:247], v15, s[24:27], s40 offen offset:1024
v_mfma_f32_16x16x32_bf16 v[172:175], a[140:143], a[44:47], v[172:175]
v_mfma_f32_16x16x32_bf16 v[168:171], a[140:143], a[40:43], v[168:171]
v_mfma_f32_16x16x32_bf16 v[164:167], a[140:143], a[36:39], v[164:167]
v_mfma_f32_16x16x32_bf16 v[160:163], a[140:143], a[32:35], v[160:163]
buffer_load_dwordx4 a[248:251], v15, s[24:27], s40 offen offset:2048
v_mfma_f32_16x16x32_bf16 v[176:179], a[144:147], a[32:35], v[176:179]
v_mfma_f32_16x16x32_bf16 v[180:183], a[144:147], a[36:39], v[180:183]
v_mfma_f32_16x16x32_bf16 v[184:187], a[144:147], a[40:43], v[184:187]
v_mfma_f32_16x16x32_bf16 v[188:191], a[144:147], a[44:47], v[188:191]
s_waitcnt vmcnt(21) lgkmcnt(0)
buffer_load_dwordx4 a[252:255], v15, s[24:27], s40 offen offset:3072
v_mfma_f32_16x16x32_bf16 v[192:195], a[148:151], a[48:51], v[192:195]
ds_read_b128 a[0:3], v4 offset:47936
ds_read_b128 a[4:7], v4 offset:52544
v_mfma_f32_16x16x32_bf16 v[196:199], a[148:151], a[52:55], v[196:199]
ds_read_b128 a[8:11], v4 offset:57152
ds_read_b128 a[12:15], v4 offset:61760
v_mfma_f32_16x16x32_bf16 v[200:203], a[148:151], a[56:59], v[200:203]
v_fmac_f32 v208, s6, v144
v_fmac_f32_e64 v209, s6, v145
v_mfma_f32_16x16x32_bf16 v[204:207], a[148:151], a[60:63], v[204:207]
v_fmac_f32 v192, s6, v128
v_fmac_f32 v193, s6, v129
v_mfma_f32_16x16x32_bf16 v[220:223], a[156:159], a[60:63], v[220:223]
s_add_u32 s40, s40, 16384
buffer_load_dwordx4 a[72:75], v12, s[24:27], s40 offen offset:0
v_fmac_f32_e64 v194, s6, v130
v_mfma_f32_16x16x32_bf16 v[216:219], a[156:159], a[56:59], v[216:219]
v_fmac_f32 v195, s6, v131
v_fmac_f32 v196, s6, v132
v_mfma_f32_16x16x32_bf16 v[212:215], a[156:159], a[52:55], v[212:215]
v_fmac_f32 v197, s6, v133
v_fmac_f32 v198, s6, v134
v_mfma_f32_16x16x32_bf16 v[208:211], a[156:159], a[48:51], v[208:211]
v_fmac_f32 v199, s6, v135
v_fmac_f32 v200, s6, v136
v_mfma_f32_16x16x32_bf16 v[224:227], a[160:163], a[48:51], v[224:227]
buffer_load_dwordx4 a[64:67], v12, s[24:27], s40 offen offset:1024
v_fmac_f32_e64 v201, s6, v137
v_mfma_f32_16x16x32_bf16 v[228:231], a[160:163], a[52:55], v[228:231]
v_fmac_f32 v202, s6, v138
v_fmac_f32 v203, s6, v139
v_mfma_f32_16x16x32_bf16 v[232:235], a[160:163], a[56:59], v[232:235]
v_fmac_f32 v204, s6, v140
v_fmac_f32 v205, s6, v141
v_mfma_f32_16x16x32_bf16 v[236:239], a[160:163], a[60:63], v[236:239]
v_fmac_f32 v206, s6, v142
v_fmac_f32 v207, s6, v143
v_mfma_f32_16x16x32_bf16 v[252:255], a[164:167], a[60:63], v[252:255]
v_fmac_f32 v210, s6, v146
v_fmac_f32 v211, s6, v147
v_mfma_f32_16x16x32_bf16 v[248:251], a[164:167], a[56:59], v[248:251]
buffer_load_dwordx4 a[68:71], v12, s[24:27], s40 offen offset:2048
v_fmac_f32_e64 v212, s6, v148
v_mfma_f32_16x16x32_bf16 v[244:247], a[164:167], a[52:55], v[244:247]
v_fmac_f32 v213, s6, v149
v_fmac_f32 v214, s6, v150
v_mfma_f32_16x16x32_bf16 v[240:243], a[164:167], a[48:51], v[240:243]
s_waitcnt vmcnt(21) lgkmcnt(0)
v_fmac_f32 v215, s6, v151
v_fmac_f32_e64 v216, s6, v152
v_mfma_f32_16x16x32_bf16 v[192:195], a[168:171], a[0:3], v[192:195]
ds_read_b128 a[16:19], v4 offset:48000
ds_read_b128 a[20:23], v4 offset:52608
v_mfma_f32_16x16x32_bf16 v[196:199], a[168:171], a[4:7], v[196:199]
buffer_load_dwordx4 a[76:79], v12, s[24:27], s40 offen offset:3072
ds_read_b128 a[24:27], v4 offset:57216
v_mfma_f32_16x16x32_bf16 v[200:203], a[168:171], a[8:11], v[200:203]
ds_read_b128 a[28:31], v4 offset:61824
v_fmac_f32_e64 v217, s6, v153
v_mfma_f32_16x16x32_bf16 v[204:207], a[168:171], a[12:15], v[204:207]
v_fmac_f32 v224, s6, v160
v_fmac_f32 v225, s6, v161
v_mfma_f32_16x16x32_bf16 v[220:223], a[172:175], a[12:15], v[220:223]
v_fmac_f32 v226, s6, v162
v_fmac_f32 v227, s6, v163
v_mfma_f32_16x16x32_bf16 v[216:219], a[172:175], a[8:11], v[216:219]
v_fmac_f32 v228, s6, v164
v_fmac_f32 v229, s6, v165
v_mfma_f32_16x16x32_bf16 v[212:215], a[172:175], a[4:7], v[212:215]
buffer_load_dwordx4 a[80:83], v13, s[24:27], s40 offen offset:0
v_fmac_f32_e64 v230, s6, v166
v_mfma_f32_16x16x32_bf16 v[208:211], a[172:175], a[0:3], v[208:211]
v_fmac_f32 v220, s6, v156
v_fmac_f32 v221, s6, v157
v_mfma_f32_16x16x32_bf16 v[224:227], a[176:179], a[0:3], v[224:227]
v_fmac_f32 v218, s6, v154
v_fmac_f32 v219, s6, v155
v_mfma_f32_16x16x32_bf16 v[228:231], a[176:179], a[4:7], v[228:231]
v_fmac_f32 v222, s6, v158
v_fmac_f32 v223, s6, v159
v_mfma_f32_16x16x32_bf16 v[232:235], a[176:179], a[8:11], v[232:235]
buffer_load_dwordx4 a[92:95], v13, s[24:27], s40 offen offset:1024
v_fmac_f32_e64 v240, s6, v176
v_mfma_f32_16x16x32_bf16 v[236:239], a[176:179], a[12:15], v[236:239]
v_fmac_f32 v241, s6, v177
v_fmac_f32 v242, s6, v178
v_mfma_f32_16x16x32_bf16 v[252:255], a[180:183], a[12:15], v[252:255]
v_fmac_f32 v231, s6, v167
v_fmac_f32 v243, s6, v179
v_mfma_f32_16x16x32_bf16 v[248:251], a[180:183], a[8:11], v[248:251]
v_fmac_f32 v232, s6, v168
v_fmac_f32 v233, s6, v169
v_mfma_f32_16x16x32_bf16 v[244:247], a[180:183], a[4:7], v[244:247]
buffer_load_dwordx4 a[84:87], v13, s[24:27], s40 offen offset:2048
v_fmac_f32_e64 v234, s6, v170
v_mfma_f32_16x16x32_bf16 v[240:243], a[180:183], a[0:3], v[240:243]
s_waitcnt vmcnt(21) lgkmcnt(0)
v_fmac_f32 v235, s6, v171
v_fmac_f32_e64 v236, s6, v172
v_mfma_f32_16x16x32_bf16 v[192:195], a[184:187], a[16:19], v[192:195]
ds_read_b128 a[32:35], v4 offset:48064
ds_read_b128 a[36:39], v4 offset:52672
v_mfma_f32_16x16x32_bf16 v[196:199], a[184:187], a[20:23], v[196:199]
ds_read_b128 a[40:43], v4 offset:57280
ds_read_b128 a[44:47], v4 offset:61888
v_mfma_f32_16x16x32_bf16 v[200:203], a[184:187], a[24:27], v[200:203]
v_fmac_f32 v237, s6, v173
v_fmac_f32 v238, s6, v174
v_mfma_f32_16x16x32_bf16 v[204:207], a[184:187], a[28:31], v[204:207]
buffer_load_dwordx4 a[88:91], v13, s[24:27], s40 offen offset:3072
v_fmac_f32_e64 v239, s6, v175
v_mfma_f32_16x16x32_bf16 v[220:223], a[188:191], a[28:31], v[220:223]
v_fmac_f32 v244, s6, v180
v_fmac_f32 v245, s6, v181
v_mfma_f32_16x16x32_bf16 v[216:219], a[188:191], a[24:27], v[216:219]
v_fmac_f32 v246, s6, v182
v_fmac_f32 v247, s6, v183
v_mfma_f32_16x16x32_bf16 v[212:215], a[188:191], a[20:23], v[212:215]
v_fmac_f32 v248, s6, v184
v_fmac_f32 v249, s6, v185
v_mfma_f32_16x16x32_bf16 v[208:211], a[188:191], a[16:19], v[208:211]
buffer_load_dwordx4 a[96:99], v14, s[24:27], s40 offen offset:0
v_fmac_f32_e64 v250, s6, v186
v_mfma_f32_16x16x32_bf16 v[224:227], a[192:195], a[16:19], v[224:227]
v_fmac_f32 v251, s6, v187
v_fmac_f32 v252, s6, v188
v_mfma_f32_16x16x32_bf16 v[228:231], a[192:195], a[20:23], v[228:231]
v_fmac_f32 v253, s6, v189
v_fmac_f32 v254, s6, v190
v_mfma_f32_16x16x32_bf16 v[232:235], a[192:195], a[24:27], v[232:235]
v_mfma_f32_16x16x32_bf16 v[236:239], a[192:195], a[28:31], v[236:239]
v_mfma_f32_16x16x32_bf16 v[252:255], a[196:199], a[28:31], v[252:255]
buffer_load_dwordx4 a[100:103], v14, s[24:27], s40 offen offset:1024
v_mfma_f32_16x16x32_bf16 v[248:251], a[196:199], a[24:27], v[248:251]
v_mfma_f32_16x16x32_bf16 v[244:247], a[196:199], a[20:23], v[244:247]
v_mfma_f32_16x16x32_bf16 v[240:243], a[196:199], a[16:19], v[240:243]
s_waitcnt vmcnt(20) lgkmcnt(0)
v_mfma_f32_16x16x32_bf16 v[192:195], a[200:203], a[32:35], v[192:195]
buffer_load_dwordx4 a[112:115], v14, s[24:27], s40 offen offset:2048
ds_read_b128 a[48:51], v5 offset:45600
v_mfma_f32_16x16x32_bf16 v[196:199], a[200:203], a[36:39], v[196:199]
ds_read_b128 a[52:55], v5 offset:50208
ds_read_b128 a[56:59], v5 offset:54816
v_mfma_f32_16x16x32_bf16 v[200:203], a[200:203], a[40:43], v[200:203]
ds_read_b128 a[60:63], v5 offset:59424
v_fmac_f32 v255, s6, v191
v_mfma_f32_16x16x32_bf16 v[204:207], a[200:203], a[44:47], v[204:207]
v_mfma_f32_16x16x32_bf16 v[220:223], a[204:207], a[44:47], v[220:223]
buffer_load_dwordx4 a[132:135], v14, s[24:27], s40 offen offset:3072
v_mfma_f32_16x16x32_bf16 v[216:219], a[204:207], a[40:43], v[216:219]
v_mfma_f32_16x16x32_bf16 v[212:215], a[204:207], a[36:39], v[212:215]
v_mfma_f32_16x16x32_bf16 v[208:211], a[204:207], a[32:35], v[208:211]
v_mfma_f32_16x16x32_bf16 v[224:227], a[208:211], a[32:35], v[224:227]
v_mfma_f32_16x16x32_bf16 v[228:231], a[208:211], a[36:39], v[228:231]
buffer_load_dwordx4 a[152:155], v15, s[24:27], s40 offen offset:0
v_mfma_f32_16x16x32_bf16 v[232:235], a[208:211], a[40:43], v[232:235]
v_mfma_f32_16x16x32_bf16 v[236:239], a[208:211], a[44:47], v[236:239]
v_mfma_f32_16x16x32_bf16 v[252:255], a[212:215], a[44:47], v[252:255]
v_mfma_f32_16x16x32_bf16 v[248:251], a[212:215], a[40:43], v[248:251]
buffer_load_dwordx4 a[104:107], v15, s[24:27], s40 offen offset:1024
v_mfma_f32_16x16x32_bf16 v[244:247], a[212:215], a[36:39], v[244:247]
v_mfma_f32_16x16x32_bf16 v[240:243], a[212:215], a[32:35], v[240:243]
s_waitcnt vmcnt(20) lgkmcnt(0)
v_mfma_f32_16x16x32_bf16 v[192:195], a[216:219], a[48:51], v[192:195]
ds_read_b128 a[0:3], v4 offset:45600
ds_read_b128 a[4:7], v4 offset:50208
v_mfma_f32_16x16x32_bf16 v[196:199], a[216:219], a[52:55], v[196:199]
ds_read_b128 a[8:11], v4 offset:54816
ds_read_b128 a[12:15], v4 offset:59424
v_mfma_f32_16x16x32_bf16 v[200:203], a[216:219], a[56:59], v[200:203]
buffer_load_dwordx4 a[108:111], v15, s[24:27], s40 offen offset:2048
v_mfma_f32_16x16x32_bf16 v[204:207], a[216:219], a[60:63], v[204:207]
L_isl2:
s_cbranch_execz L_wret
v_mfma_f32_16x16x32_bf16 v[220:223], a[220:223], a[60:63], v[220:223]
v_mfma_f32_16x16x32_bf16 v[216:219], a[220:223], a[56:59], v[216:219]
v_mfma_f32_16x16x32_bf16 v[212:215], a[220:223], a[52:55], v[212:215]
buffer_load_dwordx4 a[116:119], v15, s[24:27], s40 offen offset:3072
v_mfma_f32_16x16x32_bf16 v[208:211], a[220:223], a[48:51], v[208:211]
v_mfma_f32_16x16x32_bf16 v[224:227], a[224:227], a[48:51], v[224:227]
v_mfma_f32_16x16x32_bf16 v[228:231], a[224:227], a[52:55], v[228:231]
v_mfma_f32_16x16x32_bf16 v[232:235], a[224:227], a[56:59], v[232:235]
s_add_u32 s40, s40, 16384
buffer_load_dwordx4 a[120:123], v12, s[24:27], s40 offen offset:0
v_mfma_f32_16x16x32_bf16 v[236:239], a[224:227], a[60:63], v[236:239]
v_mfma_f32_16x16x32_bf16 v[252:255], a[228:231], a[60:63], v[252:255]
v_mfma_f32_16x16x32_bf16 v[248:251], a[228:231], a[56:59], v[248:251]
v_mfma_f32_16x16x32_bf16 v[244:247], a[228:231], a[52:55], v[244:247]
v_mfma_f32_16x16x32_bf16 v[240:243], a[228:231], a[48:51], v[240:243]
s_waitcnt vmcnt(19) lgkmcnt(0)
buffer_load_dwordx4 a[124:127], v12, s[24:27], s40 offen offset:1024
v_mfma_f32_16x16x32_bf16 v[192:195], a[232:235], a[0:3], v[192:195]
ds_read_b128 a[16:19], v4 offset:45664
ds_read_b128 a[20:23], v4 offset:50272
v_mfma_f32_16x16x32_bf16 v[196:199], a[232:235], a[4:7], v[196:199]
ds_read_b128 a[24:27], v4 offset:54880
ds_read_b128 a[28:31], v4 offset:59488
v_mfma_f32_16x16x32_bf16 v[200:203], a[232:235], a[8:11], v[200:203]
v_mfma_f32_16x16x32_bf16 v[204:207], a[232:235], a[12:15], v[204:207]
buffer_load_dwordx4 a[128:131], v12, s[24:27], s40 offen offset:2048
v_mfma_f32_16x16x32_bf16 v[220:223], a[236:239], a[12:15], v[220:223]
v_mfma_f32_16x16x32_bf16 v[216:219], a[236:239], a[8:11], v[216:219]
v_mfma_f32_16x16x32_bf16 v[212:215], a[236:239], a[4:7], v[212:215]
v_mfma_f32_16x16x32_bf16 v[208:211], a[236:239], a[0:3], v[208:211]
v_mfma_f32_16x16x32_bf16 v[224:227], a[240:243], a[0:3], v[224:227]
buffer_load_dwordx4 a[136:139], v12, s[24:27], s40 offen offset:3072
v_mfma_f32_16x16x32_bf16 v[228:231], a[240:243], a[4:7], v[228:231]
v_mfma_f32_16x16x32_bf16 v[232:235], a[240:243], a[8:11], v[232:235]
v_mfma_f32_16x16x32_bf16 v[236:239], a[240:243], a[12:15], v[236:239]
v_mfma_f32_16x16x32_bf16 v[252:255], a[244:247], a[12:15], v[252:255]
buffer_load_dwordx4 a[140:143], v13, s[24:27], s40 offen offset:0
v_mfma_f32_16x16x32_bf16 v[248:251], a[244:247], a[8:11], v[248:251]
v_mfma_f32_16x16x32_bf16 v[244:247], a[244:247], a[4:7], v[244:247]
v_mfma_f32_16x16x32_bf16 v[240:243], a[244:247], a[0:3], v[240:243]
s_waitcnt vmcnt(19) lgkmcnt(0)
v_mfma_f32_16x16x32_bf16 v[192:195], a[248:251], a[16:19], v[192:195]
ds_read_b128 a[32:35], v4 offset:45728
ds_read_b128 a[36:39], v4 offset:50336
v_mfma_f32_16x16x32_bf16 v[196:199], a[248:251], a[20:23], v[196:199]
buffer_load_dwordx4 a[144:147], v13, s[24:27], s40 offen offset:1024
ds_read_b128 a[40:43], v4 offset:54944
v_mfma_f32_16x16x32_bf16 v[200:203], a[248:251], a[24:27], v[200:203]
ds_read_b128 a[44:47], v4 offset:59552
v_mfma_f32_16x16x32_bf16 v[204:207], a[248:251], a[28:31], v[204:207]
v_mfma_f32_16x16x32_bf16 v[220:223], a[252:255], a[28:31], v[220:223]
v_mfma_f32_16x16x32_bf16 v[216:219], a[252:255], a[24:27], v[216:219]
buffer_load_dwordx4 a[148:151], v13, s[24:27], s40 offen offset:2048
v_mfma_f32_16x16x32_bf16 v[212:215], a[252:255], a[20:23], v[212:215]
v_mfma_f32_16x16x32_bf16 v[208:211], a[252:255], a[16:19], v[208:211]
v_mfma_f32_16x16x32_bf16 v[224:227], a[72:75], a[16:19], v[224:227]
v_mfma_f32_16x16x32_bf16 v[228:231], a[72:75], a[20:23], v[228:231]
buffer_load_dwordx4 a[156:159], v13, s[24:27], s40 offen offset:3072
v_mfma_f32_16x16x32_bf16 v[232:235], a[72:75], a[24:27], v[232:235]
v_mfma_f32_16x16x32_bf16 v[236:239], a[72:75], a[28:31], v[236:239]
v_mfma_f32_16x16x32_bf16 v[252:255], a[64:67], a[28:31], v[252:255]
v_mfma_f32_16x16x32_bf16 v[248:251], a[64:67], a[24:27], v[248:251]
v_mfma_f32_16x16x32_bf16 v[244:247], a[64:67], a[20:23], v[244:247]
buffer_load_dwordx4 a[160:163], v14, s[24:27], s40 offen offset:0
v_mfma_f32_16x16x32_bf16 v[240:243], a[64:67], a[16:19], v[240:243]
s_waitcnt vmcnt(19) lgkmcnt(0)
v_mfma_f32_16x16x32_bf16 v[192:195], a[68:71], a[32:35], v[192:195]
ds_read_b128 a[48:51], v4 offset:45792
ds_read_b128 a[52:55], v4 offset:50400
v_mfma_f32_16x16x32_bf16 v[196:199], a[68:71], a[36:39], v[196:199]
ds_read_b128 a[56:59], v4 offset:55008
ds_read_b128 a[60:63], v4 offset:59616
v_mfma_f32_16x16x32_bf16 v[200:203], a[68:71], a[40:43], v[200:203]
buffer_load_dwordx4 a[164:167], v14, s[24:27], s40 offen offset:1024
v_mfma_f32_16x16x32_bf16 v[204:207], a[68:71], a[44:47], v[204:207]
v_mfma_f32_16x16x32_bf16 v[220:223], a[76:79], a[44:47], v[220:223]
v_mfma_f32_16x16x32_bf16 v[216:219], a[76:79], a[40:43], v[216:219]
v_mfma_f32_16x16x32_bf16 v[212:215], a[76:79], a[36:39], v[212:215]
v_mfma_f32_16x16x32_bf16 v[208:211], a[76:79], a[32:35], v[208:211]
buffer_load_dwordx4 a[168:171], v14, s[24:27], s40 offen offset:2048
v_mfma_f32_16x16x32_bf16 v[224:227], a[80:83], a[32:35], v[224:227]
v_mfma_f32_16x16x32_bf16 v[228:231], a[80:83], a[36:39], v[228:231]
v_mfma_f32_16x16x32_bf16 v[232:235], a[80:83], a[40:43], v[232:235]
v_mfma_f32_16x16x32_bf16 v[236:239], a[80:83], a[44:47], v[236:239]
buffer_load_dwordx4 a[172:175], v14, s[24:27], s40 offen offset:3072
v_mfma_f32_16x16x32_bf16 v[252:255], a[92:95], a[44:47], v[252:255]
v_mfma_f32_16x16x32_bf16 v[248:251], a[92:95], a[40:43], v[248:251]
v_mfma_f32_16x16x32_bf16 v[244:247], a[92:95], a[36:39], v[244:247]
v_mfma_f32_16x16x32_bf16 v[240:243], a[92:95], a[32:35], v[240:243]
s_waitcnt vmcnt(18) lgkmcnt(0)
buffer_load_dwordx4 a[176:179], v15, s[24:27], s40 offen offset:0
v_mfma_f32_16x16x32_bf16 v[192:195], a[84:87], a[48:51], v[192:195]
ds_read_b128 a[0:3], v6 offset:2272
ds_read_b128 a[4:7], v6 offset:6880
v_mfma_f32_16x16x32_bf16 v[196:199], a[84:87], a[52:55], v[196:199]
ds_read_b128 a[8:11], v6 offset:11488
ds_read_b128 a[12:15], v6 offset:16096
v_mfma_f32_16x16x32_bf16 v[200:203], a[84:87], a[56:59], v[200:203]
v_mfma_f32_16x16x32_bf16 v[204:207], a[84:87], a[60:63], v[204:207]
v_mfma_f32_16x16x32_bf16 v[220:223], a[88:91], a[60:63], v[220:223]
buffer_load_dwordx4 a[180:183], v15, s[24:27], s40 offen offset:1024
v_mfma_f32_16x16x32_bf16 v[216:219], a[88:91], a[56:59], v[216:219]
v_mfma_f32_16x16x32_bf16 v[212:215], a[88:91], a[52:55], v[212:215]
v_mfma_f32_16x16x32_bf16 v[208:211], a[88:91], a[48:51], v[208:211]
v_mfma_f32_16x16x32_bf16 v[224:227], a[96:99], a[48:51], v[224:227]
buffer_load_dwordx4 a[184:187], v15, s[24:27], s40 offen offset:2048
v_mfma_f32_16x16x32_bf16 v[228:231], a[96:99], a[52:55], v[228:231]
v_mfma_f32_16x16x32_bf16 v[232:235], a[96:99], a[56:59], v[232:235]
v_mfma_f32_16x16x32_bf16 v[236:239], a[96:99], a[60:63], v[236:239]
v_mfma_f32_16x16x32_bf16 v[252:255], a[100:103], a[60:63], v[252:255]
v_mfma_f32_16x16x32_bf16 v[248:251], a[100:103], a[56:59], v[248:251]
buffer_load_dwordx4 a[188:191], v15, s[24:27], s40 offen offset:3072
v_mfma_f32_16x16x32_bf16 v[244:247], a[100:103], a[52:55], v[244:247]
v_mfma_f32_16x16x32_bf16 v[240:243], a[100:103], a[48:51], v[240:243]
s_waitcnt vmcnt(17) lgkmcnt(0)
v_mfma_f32_16x16x32_bf16 v[128:131], a[112:115], a[0:3], v[128:131]
ds_read_b128 a[16:19], v6 offset:2336
ds_read_b128 a[20:23], v6 offset:6944
v_mfma_f32_16x16x32_bf16 v[132:135], a[112:115], a[4:7], v[132:135]
s_add_u32 s40, s40, 16384
buffer_load_dwordx4 a[192:195], v12, s[24:27], s40 offen offset:0
ds_read_b128 a[24:27], v6 offset:11552
v_mfma_f32_16x16x32_bf16 v[136:139], a[112:115], a[8:11], v[136:139]
s_barrier
ds_read_b128 a[28:31], v6 offset:16160
v_fmac_f32_e64 v128, s7, v192
v_mfma_f32_16x16x32_bf16 v[140:143], a[112:115], a[12:15], v[140:143]
v_fmac_f32 v129, s7, v193
v_fmac_f32 v130, s7, v194
v_mfma_f32_16x16x32_bf16 v[156:159], a[132:135], a[12:15], v[156:159]
v_fmac_f32 v131, s7, v195
v_fmac_f32 v132, s7, v196
v_mfma_f32_16x16x32_bf16 v[152:155], a[132:135], a[8:11], v[152:155]
buffer_load_dwordx4 a[196:199], v12, s[24:27], s40 offen offset:1024
v_fmac_f32_e64 v133, s7, v197
v_mfma_f32_16x16x32_bf16 v[148:151], a[132:135], a[4:7], v[148:151]
v_fmac_f32 v134, s7, v198
v_fmac_f32 v135, s7, v199
v_mfma_f32_16x16x32_bf16 v[144:147], a[132:135], a[0:3], v[144:147]
v_fmac_f32 v136, s7, v200
v_fmac_f32 v137, s7, v201
v_mfma_f32_16x16x32_bf16 v[88:91], v[20:23], v[76:79], 0
v_fmac_f32 v138, s7, v202
v_fmac_f32 v139, s7, v203
v_mfma_f32_16x16x32_bf16 v[112:115], a[152:155], a[0:3], v[112:115]
v_fmac_f32 v140, s7, v204
v_fmac_f32 v141, s7, v205
v_mfma_f32_16x16x32_bf16 v[116:119], a[152:155], a[4:7], v[116:119]
buffer_load_dwordx4 a[200:203], v12, s[24:27], s40 offen offset:2048
v_fmac_f32_e64 v142, s7, v206
v_mfma_f32_16x16x32_bf16 v[120:123], a[152:155], a[8:11], v[120:123]
v_fmac_f32 v143, s7, v207
v_fmac_f32 v144, s7, v208
v_mfma_f32_16x16x32_bf16 v[124:127], a[152:155], a[12:15], v[124:127]
v_fmac_f32 v145, s7, v209
v_fmac_f32 v146, s7, v210
v_mfma_f32_16x16x32_bf16 v[172:175], a[104:107], a[12:15], v[172:175]
v_fmac_f32 v147, s7, v211
v_fmac_f32 v148, s7, v212
v_mfma_f32_16x16x32_bf16 v[168:171], a[104:107], a[8:11], v[168:171]
buffer_load_dwordx4 a[204:207], v12, s[24:27], s40 offen offset:3072
v_fmac_f32_e64 v149, s7, v213
v_mfma_f32_16x16x32_bf16 v[92:95], v[20:23], v[80:83], 0
v_cvt_pk_bf16_f32 v88, v88, v89
v_cvt_pk_bf16_f32 v89, v90, v91
v_mfma_f32_16x16x32_bf16 v[164:167], a[104:107], a[4:7], v[164:167]
ds_write_b64 v10, v[88:89] offset:0
v_mfma_f32_16x16x32_bf16 v[160:163], a[104:107], a[0:3], v[160:163]
v_fmac_f32 v150, s7, v214
v_fmac_f32 v151, s7, v215
v_mfma_f32_16x16x32_bf16 v[176:179], a[108:111], a[0:3], v[176:179]
v_fmac_f32 v152, s7, v216
v_fmac_f32 v153, s7, v217
v_mfma_f32_16x16x32_bf16 v[180:183], a[108:111], a[4:7], v[180:183]
buffer_load_dwordx4 a[208:211], v13, s[24:27], s40 offen offset:0
v_fmac_f32_e64 v154, s7, v218
v_mfma_f32_16x16x32_bf16 v[184:187], a[108:111], a[8:11], v[184:187]
v_fmac_f32 v155, s7, v219
v_fmac_f32 v156, s7, v220
v_mfma_f32_16x16x32_bf16 v[188:191], a[108:111], a[12:15], v[188:191]
s_waitcnt vmcnt(17) lgkmcnt(1)
v_fmac_f32 v157, s7, v221
v_fmac_f32_e64 v158, s7, v222
v_mfma_f32_16x16x32_bf16 v[128:131], a[116:119], a[16:19], v[128:131]
ds_read_b128 a[32:35], v6 offset:2400
ds_read_b128 a[36:39], v6 offset:7008
v_mfma_f32_16x16x32_bf16 v[88:91], v[20:23], v[84:87], 0
buffer_load_dwordx4 a[212:215], v13, s[24:27], s40 offen offset:1024
ds_read_b128 a[40:43], v6 offset:11616
v_mfma_f32_16x16x32_bf16 v[132:135], a[116:119], a[20:23], v[132:135]
ds_read_b128 a[44:47], v6 offset:16224
v_cvt_pk_bf16_f32 v92, v92, v93
v_mfma_f32_16x16x32_bf16 v[136:139], a[116:119], a[24:27], v[136:139]
v_cvt_pk_bf16_f32 v93, v94, v95
v_fmac_f32_e64 v160, s7, v224
v_mfma_f32_16x16x32_bf16 v[140:143], a[116:119], a[28:31], v[140:143]
ds_write_b64 v10, v[92:93] offset:2304
v_mfma_f32_16x16x32_bf16 v[156:159], a[120:123], a[28:31], v[156:159]
v_fmac_f32 v161, s7, v225
v_fmac_f32 v162, s7, v226
v_mfma_f32_16x16x32_bf16 v[152:155], a[120:123], a[24:27], v[152:155]
buffer_load_dwordx4 a[216:219], v13, s[24:27], s40 offen offset:2048
v_fmac_f32_e64 v163, s7, v227
v_mfma_f32_16x16x32_bf16 v[148:151], a[120:123], a[20:23], v[148:151]
v_fmac_f32 v164, s7, v228
v_fmac_f32 v165, s7, v229
v_mfma_f32_16x16x32_bf16 v[92:95], v[24:27], v[76:79], 0
v_cvt_pk_bf16_f32 v88, v88, v89
v_cvt_pk_bf16_f32 v89, v90, v91
v_mfma_f32_16x16x32_bf16 v[144:147], a[120:123], a[16:19], v[144:147]
ds_write_b64 v10, v[88:89] offset:4608
v_mfma_f32_16x16x32_bf16 v[112:115], a[124:127], a[16:19], v[112:115]
buffer_load_dwordx4 a[220:223], v13, s[24:27], s40 offen offset:3072
v_fmac_f32_e64 v159, s7, v223
v_mfma_f32_16x16x32_bf16 v[116:119], a[124:127], a[20:23], v[116:119]
v_fmac_f32 v166, s7, v230
v_fmac_f32 v167, s7, v231
v_mfma_f32_16x16x32_bf16 v[120:123], a[124:127], a[24:27], v[120:123]
v_fmac_f32 v168, s7, v232
v_fmac_f32 v169, s7, v233
v_mfma_f32_16x16x32_bf16 v[124:127], a[124:127], a[28:31], v[124:127]
v_fmac_f32 v170, s7, v234
v_fmac_f32 v171, s7, v235
v_mfma_f32_16x16x32_bf16 v[172:175], a[128:131], a[28:31], v[172:175]
buffer_load_dwordx4 a[224:227], v14, s[24:27], s40 offen offset:0
v_fmac_f32_e64 v176, s7, v240
v_mfma_f32_16x16x32_bf16 v[88:91], v[24:27], v[80:83], 0
v_cvt_pk_bf16_f32 v92, v92, v93
v_cvt_pk_bf16_f32 v93, v94, v95
v_mfma_f32_16x16x32_bf16 v[168:171], a[128:131], a[24:27], v[168:171]
ds_write_b64 v10, v[92:93] offset:32
v_mfma_f32_16x16x32_bf16 v[164:167], a[128:131], a[20:23], v[164:167]
v_fmac_f32 v172, s7, v236
v_fmac_f32 v173, s7, v237
v_mfma_f32_16x16x32_bf16 v[160:163], a[128:131], a[16:19], v[160:163]
v_fmac_f32 v174, s7, v238
v_fmac_f32 v175, s7, v239
v_mfma_f32_16x16x32_bf16 v[176:179], a[136:139], a[16:19], v[176:179]
buffer_load_dwordx4 a[228:231], v14, s[24:27], s40 offen offset:1024
v_fmac_f32_e64 v188, s7, v252
v_mfma_f32_16x16x32_bf16 v[180:183], a[136:139], a[20:23], v[180:183]
v_fmac_f32 v189, s7, v253
v_fmac_f32 v190, s7, v254
v_mfma_f32_16x16x32_bf16 v[184:187], a[136:139], a[24:27], v[184:187]
v_fmac_f32 v112, s80, v96
v_fmac_f32 v113, s80, v97
v_mfma_f32_16x16x32_bf16 v[92:95], v[24:27], v[84:87], 0
v_cvt_pk_bf16_f32 v88, v88, v89
v_cvt_pk_bf16_f32 v89, v90, v91
v_mfma_f32_16x16x32_bf16 v[188:191], a[136:139], a[28:31], v[188:191]
s_waitcnt vmcnt(17) lgkmcnt(3)
buffer_load_dwordx4 a[232:235], v14, s[24:27], s40 offen offset:2048
v_fmac_f32 v177, s7, v241
v_mfma_f32_16x16x32_bf16 v[128:131], a[140:143], a[32:35], v[128:131]
ds_read_b128 a[48:51], v6 offset:2464
ds_read_b128 a[52:55], v6 offset:7072
v_mfma_f32_16x16x32_bf16 v[132:135], a[140:143], a[36:39], v[132:135]
ds_read_b128 a[56:59], v6 offset:11680
ds_read_b128 a[60:63], v6 offset:16288
v_mfma_f32_16x16x32_bf16 v[136:139], a[140:143], a[40:43], v[136:139]
ds_write_b64 v10, v[88:89] offset:2336
v_mfma_f32_16x16x32_bf16 v[140:143], a[140:143], a[44:47], v[140:143]
v_fmac_f32 v178, s7, v242
v_fmac_f32 v179, s7, v243
v_mfma_f32_16x16x32_bf16 v[156:159], a[144:147], a[44:47], v[156:159]
buffer_load_dwordx4 a[236:239], v14, s[24:27], s40 offen offset:3072
v_fmac_f32_e64 v180, s7, v244
v_mfma_f32_16x16x32_bf16 v[88:91], v[28:31], v[76:79], 0
v_cvt_pk_bf16_f32 v92, v92, v93
v_cvt_pk_bf16_f32 v93, v94, v95
v_mfma_f32_16x16x32_bf16 v[152:155], a[144:147], a[40:43], v[152:155]
ds_write_b64 v10, v[92:93] offset:4640
v_mfma_f32_16x16x32_bf16 v[148:151], a[144:147], a[36:39], v[148:151]
v_fmac_f32 v181, s7, v245
v_fmac_f32 v182, s7, v246
v_mfma_f32_16x16x32_bf16 v[144:147], a[144:147], a[32:35], v[144:147]
buffer_load_dwordx4 a[240:243], v15, s[24:27], s40 offen offset:0
v_fmac_f32_e64 v183, s7, v247
v_mfma_f32_16x16x32_bf16 v[112:115], a[148:151], a[32:35], v[112:115]
v_fmac_f32 v184, s7, v248
v_fmac_f32 v185, s7, v249
v_mfma_f32_16x16x32_bf16 v[116:119], a[148:151], a[36:39], v[116:119]
v_fmac_f32 v186, s7, v250
v_fmac_f32 v187, s7, v251
v_mfma_f32_16x16x32_bf16 v[120:123], a[148:151], a[40:43], v[120:123]
v_fmac_f32_e64 v191, s7, v255
v_mfma_f32_16x16x32_bf16 v[92:95], v[28:31], v[80:83], 0
buffer_load_dwordx4 a[244:247], v15, s[24:27], s40 offen offset:1024
v_cvt_pk_bf16_f32 v88, v88, v89
v_mfma_f32_16x16x32_bf16 v[124:127], a[148:151], a[44:47], v[124:127]
v_cvt_pk_bf16_f32 v89, v90, v91
v_fmac_f32_e64 v114, s80, v98
v_mfma_f32_16x16x32_bf16 v[172:175], a[156:159], a[44:47], v[172:175]
ds_write_b64 v10, v[88:89] offset:64
v_mfma_f32_16x16x32_bf16 v[168:171], a[156:159], a[40:43], v[168:171]
v_fmac_f32 v115, s80, v99
v_fmac_f32 v116, s80, v100
v_mfma_f32_16x16x32_bf16 v[164:167], a[156:159], a[36:39], v[164:167]
v_fmac_f32 v117, s80, v101
v_fmac_f32 v118, s80, v102
v_mfma_f32_16x16x32_bf16 v[160:163], a[156:159], a[32:35], v[160:163]
buffer_load_dwordx4 a[248:251], v15, s[24:27], s40 offen offset:2048
v_fmac_f32_e64 v119, s80, v103
v_mfma_f32_16x16x32_bf16 v[176:179], a[160:163], a[32:35], v[176:179]
v_fmac_f32 v120, s80, v104
v_fmac_f32 v121, s80, v105
v_mfma_f32_16x16x32_bf16 v[88:91], v[28:31], v[84:87], 0
v_cvt_pk_bf16_f32 v92, v92, v93
v_cvt_pk_bf16_f32 v93, v94, v95
v_mfma_f32_16x16x32_bf16 v[180:183], a[160:163], a[36:39], v[180:183]
ds_write_b64 v10, v[92:93] offset:2368
v_mfma_f32_16x16x32_bf16 v[184:187], a[160:163], a[40:43], v[184:187]
buffer_load_dwordx4 a[252:255], v15, s[24:27], s40 offen offset:3072
v_fmac_f32_e64 v122, s80, v106
v_mfma_f32_16x16x32_bf16 v[188:191], a[160:163], a[44:47], v[188:191]
s_waitcnt vmcnt(18) lgkmcnt(4)
v_fmac_f32 v123, s80, v107
v_fmac_f32_e64 v124, s80, v108
v_mfma_f32_16x16x32_bf16 v[128:131], a[164:167], a[48:51], v[128:131]
ds_read_b128 a[0:3], v7 offset:0
ds_read_b128 a[4:7], v7 offset:4608
v_mfma_f32_16x16x32_bf16 v[132:135], a[164:167], a[52:55], v[132:135]
ds_read_b128 a[8:11], v7 offset:9216
ds_read_b128 a[12:15], v7 offset:13824
v_mfma_f32_16x16x32_bf16 v[136:139], a[164:167], a[56:59], v[136:139]
v_fmac_f32 v125, s80, v109
v_fmac_f32 v126, s80, v110
v_mfma_f32_16x16x32_bf16 v[92:95], v[32:35], v[76:79], 0
s_add_u32 s40, s40, 16384
buffer_load_dwordx4 a[72:75], v12, s[24:27], s40 offen offset:0
v_cvt_pk_bf16_f32 v88, v88, v89
v_mfma_f32_16x16x32_bf16 v[140:143], a[164:167], a[60:63], v[140:143]
v_cvt_pk_bf16_f32 v89, v90, v91
v_fmac_f32_e64 v127, s80, v111
v_mfma_f32_16x16x32_bf16 v[156:159], a[168:171], a[60:63], v[156:159]
ds_write_b64 v10, v[88:89] offset:4672
v_mfma_f32_16x16x32_bf16 v[152:155], a[168:171], a[56:59], v[152:155]
v_mfma_f32_16x16x32_bf16 v[148:151], a[168:171], a[52:55], v[148:151]
buffer_load_dwordx4 a[64:67], v12, s[24:27], s40 offen offset:1024
v_mfma_f32_16x16x32_bf16 v[144:147], a[168:171], a[48:51], v[144:147]
v_mfma_f32_16x16x32_bf16 v[112:115], a[172:175], a[48:51], v[112:115]
v_mfma_f32_16x16x32_bf16 v[88:91], v[32:35], v[80:83], 0
v_cvt_pk_bf16_f32 v92, v92, v93
v_cvt_pk_bf16_f32 v93, v94, v95
v_mfma_f32_16x16x32_bf16 v[116:119], a[172:175], a[52:55], v[116:119]
buffer_load_dwordx4 a[68:71], v12, s[24:27], s40 offen offset:2048
v_mfma_f32_16x16x32_bf16 v[120:123], a[172:175], a[56:59], v[120:123]
ds_write_b64 v10, v[92:93] offset:96
v_mfma_f32_16x16x32_bf16 v[124:127], a[172:175], a[60:63], v[124:127]
v_mfma_f32_16x16x32_bf16 v[172:175], a[176:179], a[60:63], v[172:175]
v_mfma_f32_16x16x32_bf16 v[168:171], a[176:179], a[56:59], v[168:171]
v_mfma_f32_16x16x32_bf16 v[164:167], a[176:179], a[52:55], v[164:167]
buffer_load_dwordx4 a[76:79], v12, s[24:27], s40 offen offset:3072
v_mfma_f32_16x16x32_bf16 v[92:95], v[32:35], v[84:87], 0
v_cvt_pk_bf16_f32 v88, v88, v89
v_cvt_pk_bf16_f32 v89, v90, v91
v_mfma_f32_16x16x32_bf16 v[160:163], a[176:179], a[48:51], v[160:163]
ds_write_b64 v10, v[88:89] offset:2400
v_mfma_f32_16x16x32_bf16 v[176:179], a[180:183], a[48:51], v[176:179]
v_mfma_f32_16x16x32_bf16 v[180:183], a[180:183], a[52:55], v[180:183]
buffer_load_dwordx4 a[80:83], v13, s[24:27], s40 offen offset:0
v_mfma_f32_16x16x32_bf16 v[184:187], a[180:183], a[56:59], v[184:187]
v_mfma_f32_16x16x32_bf16 v[188:191], a[180:183], a[60:63], v[188:191]
s_waitcnt vmcnt(18) lgkmcnt(3)
v_mfma_f32_16x16x32_bf16 v[128:131], a[184:187], a[0:3], v[128:131]
ds_read_b128 a[16:19], v6 offset:0
ds_read_b128 a[20:23], v6 offset:4608
v_mfma_f32_16x16x32_bf16 v[88:91], v[36:39], v[76:79], 0
ds_read_b128 a[24:27], v6 offset:9216
ds_read_b128 a[28:31], v6 offset:13824
v_mfma_f32_16x16x32_bf16 v[132:135], a[184:187], a[4:7], v[132:135]
buffer_load_dwordx4 a[92:95], v13, s[24:27], s40 offen offset:1024
v_cvt_pk_bf16_f32 v92, v92, v93
v_mfma_f32_16x16x32_bf16 v[136:139], a[184:187], a[8:11], v[136:139]
v_cvt_pk_bf16_f32 v93, v94, v95
v_mfma_f32_16x16x32_bf16 v[140:143], a[184:187], a[12:15], v[140:143]
ds_write_b64 v10, v[92:93] offset:4704
v_mfma_f32_16x16x32_bf16 v[156:159], a[188:191], a[12:15], v[156:159]
v_mfma_f32_16x16x32_bf16 v[152:155], a[188:191], a[8:11], v[152:155]
buffer_load_dwordx4 a[84:87], v13, s[24:27], s40 offen offset:2048
v_mfma_f32_16x16x32_bf16 v[148:151], a[188:191], a[4:7], v[148:151]
v_mfma_f32_16x16x32_bf16 v[92:95], v[36:39], v[80:83], 0
v_cvt_pk_bf16_f32 v88, v88, v89
v_cvt_pk_bf16_f32 v89, v90, v91
v_mfma_f32_16x16x32_bf16 v[144:147], a[188:191], a[0:3], v[144:147]
ds_write_b64 v10, v[88:89] offset:6912
v_mfma_f32_16x16x32_bf16 v[112:115], a[192:195], a[0:3], v[112:115]
v_mfma_f32_16x16x32_bf16 v[116:119], a[192:195], a[4:7], v[116:119]
buffer_load_dwordx4 a[88:91], v13, s[24:27], s40 offen offset:3072
v_mfma_f32_16x16x32_bf16 v[120:123], a[192:195], a[8:11], v[120:123]
v_mfma_f32_16x16x32_bf16 v[124:127], a[192:195], a[12:15], v[124:127]
v_mfma_f32_16x16x32_bf16 v[172:175], a[196:199], a[12:15], v[172:175]
v_mfma_f32_16x16x32_bf16 v[88:91], v[36:39], v[84:87], 0
buffer_load_dwordx4 a[96:99], v14, s[24:27], s40 offen offset:0
v_cvt_pk_bf16_f32 v92, v92, v93
v_mfma_f32_16x16x32_bf16 v[168:171], a[196:199], a[8:11], v[168:171]
v_cvt_pk_bf16_f32 v93, v94, v95
v_mfma_f32_16x16x32_bf16 v[164:167], a[196:199], a[4:7], v[164:167]
ds_write_b64 v10, v[92:93] offset:9216
v_mfma_f32_16x16x32_bf16 v[160:163], a[196:199], a[0:3], v[160:163]
v_mfma_f32_16x16x32_bf16 v[176:179], a[200:203], a[0:3], v[176:179]
buffer_load_dwordx4 a[100:103], v14, s[24:27], s40 offen offset:1024
v_mfma_f32_16x16x32_bf16 v[180:183], a[200:203], a[4:7], v[180:183]
v_mfma_f32_16x16x32_bf16 v[184:187], a[200:203], a[8:11], v[184:187]
v_mfma_f32_16x16x32_bf16 v[92:95], v[40:43], v[76:79], 0
v_cvt_pk_bf16_f32 v88, v88, v89
v_cvt_pk_bf16_f32 v89, v90, v91
v_mfma_f32_16x16x32_bf16 v[188:191], a[200:203], a[12:15], v[188:191]
s_waitcnt vmcnt(18) lgkmcnt(3)
ds_write_b64 v10, v[88:89] offset:11520
v_mfma_f32_16x16x32_bf16 v[128:131], a[204:207], a[16:19], v[128:131]
buffer_load_dwordx4 a[112:115], v14, s[24:27], s40 offen offset:2048
ds_read_b128 a[32:35], v6 offset:64
v_mfma_f32_16x16x32_bf16 v[132:135], a[204:207], a[20:23], v[132:135]
ds_read_b128 a[36:39], v6 offset:4672
ds_read_b128 a[40:43], v6 offset:9280
v_mfma_f32_16x16x32_bf16 v[136:139], a[204:207], a[24:27], v[136:139]
ds_read_b128 a[44:47], v6 offset:13888
v_mfma_f32_16x16x32_bf16 v[140:143], a[204:207], a[28:31], v[140:143]
v_mfma_f32_16x16x32_bf16 v[156:159], a[208:211], a[28:31], v[156:159]
buffer_load_dwordx4 a[132:135], v14, s[24:27], s40 offen offset:3072
v_mfma_f32_16x16x32_bf16 v[88:91], v[40:43], v[80:83], 0
v_cvt_pk_bf16_f32 v92, v92, v93
v_cvt_pk_bf16_f32 v93, v94, v95
v_mfma_f32_16x16x32_bf16 v[152:155], a[208:211], a[24:27], v[152:155]
ds_write_b64 v10, v[92:93] offset:6944
v_mfma_f32_16x16x32_bf16 v[148:151], a[208:211], a[20:23], v[148:151]
v_mfma_f32_16x16x32_bf16 v[144:147], a[208:211], a[16:19], v[144:147]
v_mfma_f32_16x16x32_bf16 v[112:115], a[212:215], a[16:19], v[112:115]
buffer_load_dwordx4 a[152:155], v15, s[24:27], s40 offen offset:0
v_mfma_f32_16x16x32_bf16 v[116:119], a[212:215], a[20:23], v[116:119]
v_mfma_f32_16x16x32_bf16 v[120:123], a[212:215], a[24:27], v[120:123]
v_mfma_f32_16x16x32_bf16 v[92:95], v[40:43], v[84:87], 0
v_cvt_pk_bf16_f32 v88, v88, v89
v_cvt_pk_bf16_f32 v89, v90, v91
v_mfma_f32_16x16x32_bf16 v[124:127], a[212:215], a[28:31], v[124:127]
buffer_load_dwordx4 a[104:107], v15, s[24:27], s40 offen offset:1024
v_mfma_f32_16x16x32_bf16 v[172:175], a[216:219], a[28:31], v[172:175]
ds_write_b64 v10, v[88:89] offset:9248
v_mfma_f32_16x16x32_bf16 v[168:171], a[216:219], a[24:27], v[168:171]
v_mfma_f32_16x16x32_bf16 v[164:167], a[216:219], a[20:23], v[164:167]
v_mfma_f32_16x16x32_bf16 v[160:163], a[216:219], a[16:19], v[160:163]
buffer_load_dwordx4 a[108:111], v15, s[24:27], s40 offen offset:2048
v_mfma_f32_16x16x32_bf16 v[176:179], a[220:223], a[16:19], v[176:179]
v_mfma_f32_16x16x32_bf16 v[88:91], v[44:47], v[76:79], 0
v_cvt_pk_bf16_f32 v92, v92, v93
v_cvt_pk_bf16_f32 v93, v94, v95
v_mfma_f32_16x16x32_bf16 v[180:183], a[220:223], a[20:23], v[180:183]
ds_write_b64 v10, v[92:93] offset:11552
v_mfma_f32_16x16x32_bf16 v[184:187], a[220:223], a[24:27], v[184:187]
v_mfma_f32_16x16x32_bf16 v[188:191], a[220:223], a[28:31], v[188:191]
s_waitcnt vmcnt(18) lgkmcnt(3)
buffer_load_dwordx4 a[116:119], v15, s[24:27], s40 offen offset:3072
v_mfma_f32_16x16x32_bf16 v[128:131], a[224:227], a[32:35], v[128:131]
ds_read_b128 a[48:51], v6 offset:128
ds_read_b128 a[52:55], v6 offset:4736
v_mfma_f32_16x16x32_bf16 v[132:135], a[224:227], a[36:39], v[132:135]
ds_read_b128 a[56:59], v6 offset:9344
ds_read_b128 a[60:63], v6 offset:13952
v_mfma_f32_16x16x32_bf16 v[136:139], a[224:227], a[40:43], v[136:139]
v_mfma_f32_16x16x32_bf16 v[92:95], v[44:47], v[80:83], 0
s_add_u32 s40, s40, 16384
buffer_load_dwordx4 a[120:123], v12, s[24:27], s40 offen offset:0
v_cvt_pk_bf16_f32 v88, v88, v89
v_mfma_f32_16x16x32_bf16 v[140:143], a[224:227], a[44:47], v[140:143]
v_cvt_pk_bf16_f32 v89, v90, v91
v_mfma_f32_16x16x32_bf16 v[156:159], a[228:231], a[44:47], v[156:159]
ds_write_b64 v10, v[88:89] offset:6976
v_mfma_f32_16x16x32_bf16 v[152:155], a[228:231], a[40:43], v[152:155]
v_mfma_f32_16x16x32_bf16 v[148:151], a[228:231], a[36:39], v[148:151]
v_mfma_f32_16x16x32_bf16 v[144:147], a[228:231], a[32:35], v[144:147]
buffer_load_dwordx4 a[124:127], v12, s[24:27], s40 offen offset:1024
v_mfma_f32_16x16x32_bf16 v[112:115], a[232:235], a[32:35], v[112:115]
v_mfma_f32_16x16x32_bf16 v[88:91], v[44:47], v[84:87], 0
v_cvt_pk_bf16_f32 v92, v92, v93
v_cvt_pk_bf16_f32 v93, v94, v95
v_mfma_f32_16x16x32_bf16 v[116:119], a[232:235], a[36:39], v[116:119]
ds_write_b64 v10, v[92:93] offset:9280
v_mfma_f32_16x16x32_bf16 v[120:123], a[232:235], a[40:43], v[120:123]
buffer_load_dwordx4 a[128:131], v12, s[24:27], s40 offen offset:2048
v_mfma_f32_16x16x32_bf16 v[124:127], a[232:235], a[44:47], v[124:127]
v_mfma_f32_16x16x32_bf16 v[172:175], a[236:239], a[44:47], v[172:175]
v_mfma_f32_16x16x32_bf16 v[168:171], a[236:239], a[40:43], v[168:171]
v_mfma_f32_16x16x32_bf16 v[164:167], a[236:239], a[36:39], v[164:167]
buffer_load_dwordx4 a[136:139], v12, s[24:27], s40 offen offset:3072
v_mfma_f32_16x16x32_bf16 v[92:95], v[48:51], v[76:79], 0
v_cvt_pk_bf16_f32 v88, v88, v89
v_cvt_pk_bf16_f32 v89, v90, v91
v_mfma_f32_16x16x32_bf16 v[160:163], a[236:239], a[32:35], v[160:163]
ds_write_b64 v10, v[88:89] offset:11584
v_mfma_f32_16x16x32_bf16 v[176:179], a[240:243], a[32:35], v[176:179]
v_mfma_f32_16x16x32_bf16 v[180:183], a[240:243], a[36:39], v[180:183]
v_mfma_f32_16x16x32_bf16 v[184:187], a[240:243], a[40:43], v[184:187]
buffer_load_dwordx4 a[140:143], v13, s[24:27], s40 offen offset:0
v_mfma_f32_16x16x32_bf16 v[188:191], a[240:243], a[44:47], v[188:191]
s_waitcnt vmcnt(19) lgkmcnt(3)
v_mfma_f32_16x16x32_bf16 v[128:131], a[244:247], a[48:51], v[128:131]
ds_read_b128 a[0:3], v6 offset:192
ds_read_b128 a[4:7], v6 offset:4800
v_mfma_f32_16x16x32_bf16 v[88:91], v[48:51], v[80:83], 0
ds_read_b128 a[8:11], v6 offset:9408
ds_read_b128 a[12:15], v6 offset:14016
v_mfma_f32_16x16x32_bf16 v[132:135], a[244:247], a[52:55], v[132:135]
buffer_load_dwordx4 a[144:147], v13, s[24:27], s40 offen offset:1024
v_cvt_pk_bf16_f32 v92, v92, v93
v_mfma_f32_16x16x32_bf16 v[136:139], a[244:247], a[56:59], v[136:139]
v_cvt_pk_bf16_f32 v93, v94, v95
v_mfma_f32_16x16x32_bf16 v[140:143], a[244:247], a[60:63], v[140:143]
ds_write_b64 v10, v[92:93] offset:7008
v_mfma_f32_16x16x32_bf16 v[156:159], a[248:251], a[60:63], v[156:159]
v_mfma_f32_16x16x32_bf16 v[152:155], a[248:251], a[56:59], v[152:155]
v_mfma_f32_16x16x32_bf16 v[148:151], a[248:251], a[52:55], v[148:151]
buffer_load_dwordx4 a[148:151], v13, s[24:27], s40 offen offset:2048
v_mfma_f32_16x16x32_bf16 v[92:95], v[48:51], v[84:87], 0
v_cvt_pk_bf16_f32 v88, v88, v89
v_cvt_pk_bf16_f32 v89, v90, v91
v_mfma_f32_16x16x32_bf16 v[144:147], a[248:251], a[48:51], v[144:147]
ds_write_b64 v10, v[88:89] offset:9312
v_mfma_f32_16x16x32_bf16 v[112:115], a[252:255], a[48:51], v[112:115]
v_mfma_f32_16x16x32_bf16 v[116:119], a[252:255], a[52:55], v[116:119]
buffer_load_dwordx4 a[156:159], v13, s[24:27], s40 offen offset:3072
v_mfma_f32_16x16x32_bf16 v[120:123], a[252:255], a[56:59], v[120:123]
v_mfma_f32_16x16x32_bf16 v[124:127], a[252:255], a[60:63], v[124:127]
v_mfma_f32_16x16x32_bf16 v[172:175], a[72:75], a[60:63], v[172:175]
v_mfma_f32_16x16x32_bf16 v[88:91], v[52:55], v[76:79], 0
v_cvt_pk_bf16_f32 v92, v92, v93
v_cvt_pk_bf16_f32 v93, v94, v95
v_mfma_f32_16x16x32_bf16 v[168:171], a[72:75], a[56:59], v[168:171]
buffer_load_dwordx4 a[160:163], v14, s[24:27], s40 offen offset:0
v_mfma_f32_16x16x32_bf16 v[164:167], a[72:75], a[52:55], v[164:167]
ds_write_b64 v10, v[92:93] offset:11616
v_mfma_f32_16x16x32_bf16 v[160:163], a[72:75], a[48:51], v[160:163]
v_mfma_f32_16x16x32_bf16 v[176:179], a[64:67], a[48:51], v[176:179]
v_mfma_f32_16x16x32_bf16 v[180:183], a[64:67], a[52:55], v[180:183]
buffer_load_dwordx4 a[164:167], v14, s[24:27], s40 offen offset:1024
v_mfma_f32_16x16x32_bf16 v[184:187], a[64:67], a[56:59], v[184:187]
v_mfma_f32_16x16x32_bf16 v[92:95], v[52:55], v[80:83], 0
v_cvt_pk_bf16_f32 v88, v88, v89
v_cvt_pk_bf16_f32 v89, v90, v91
v_mfma_f32_16x16x32_bf16 v[188:191], a[64:67], a[60:63], v[188:191]
s_waitcnt vmcnt(19) lgkmcnt(3)
ds_write_b64 v10, v[88:89] offset:13824
v_mfma_f32_16x16x32_bf16 v[128:131], a[68:71], a[0:3], v[128:131]
buffer_load_dwordx4 a[168:171], v14, s[24:27], s40 offen offset:2048
ds_read_b128 a[16:19], v8 offset:2272
v_mfma_f32_16x16x32_bf16 v[132:135], a[68:71], a[4:7], v[132:135]
ds_read_b128 a[20:23], v8 offset:6880
ds_read_b128 a[24:27], v8 offset:11488
v_mfma_f32_16x16x32_bf16 v[136:139], a[68:71], a[8:11], v[136:139]
L_isl3:
s_cbranch_execz L_wret
ds_read_b128 a[28:31], v8 offset:16096
v_mfma_f32_16x16x32_bf16 v[140:143], a[68:71], a[12:15], v[140:143]
v_mfma_f32_16x16x32_bf16 v[156:159], a[76:79], a[12:15], v[156:159]
v_mfma_f32_16x16x32_bf16 v[88:91], v[52:55], v[84:87], 0
buffer_load_dwordx4 a[172:175], v14, s[24:27], s40 offen offset:3072
v_cvt_pk_bf16_f32 v92, v92, v93
v_mfma_f32_16x16x32_bf16 v[152:155], a[76:79], a[8:11], v[152:155]
v_cvt_pk_bf16_f32 v93, v94, v95
v_mfma_f32_16x16x32_bf16 v[148:151], a[76:79], a[4:7], v[148:151]
ds_write_b64 v10, v[92:93] offset:16128
v_mfma_f32_16x16x32_bf16 v[144:147], a[76:79], a[0:3], v[144:147]
v_mfma_f32_16x16x32_bf16 v[112:115], a[80:83], a[0:3], v[112:115]
buffer_load_dwordx4 a[176:179], v15, s[24:27], s40 offen offset:0
v_mfma_f32_16x16x32_bf16 v[116:119], a[80:83], a[4:7], v[116:119]
v_mfma_f32_16x16x32_bf16 v[120:123], a[80:83], a[8:11], v[120:123]
v_mfma_f32_16x16x32_bf16 v[92:95], v[56:59], v[76:79], 0
v_cvt_pk_bf16_f32 v88, v88, v89
v_cvt_pk_bf16_f32 v89, v90, v91
v_mfma_f32_16x16x32_bf16 v[124:127], a[80:83], a[12:15], v[124:127]
ds_write_b64 v10, v[88:89] offset:18432
v_mfma_f32_16x16x32_bf16 v[172:175], a[92:95], a[12:15], v[172:175]
buffer_load_dwordx4 a[180:183], v15, s[24:27], s40 offen offset:1024
v_mfma_f32_16x16x32_bf16 v[168:171], a[92:95], a[8:11], v[168:171]
v_mfma_f32_16x16x32_bf16 v[164:167], a[92:95], a[4:7], v[164:167]
v_mfma_f32_16x16x32_bf16 v[160:163], a[92:95], a[0:3], v[160:163]
v_mfma_f32_16x16x32_bf16 v[176:179], a[84:87], a[0:3], v[176:179]
buffer_load_dwordx4 a[184:187], v15, s[24:27], s40 offen offset:2048
v_mfma_f32_16x16x32_bf16 v[88:91], v[56:59], v[80:83], 0
v_cvt_pk_bf16_f32 v92, v92, v93
v_cvt_pk_bf16_f32 v93, v94, v95
v_mfma_f32_16x16x32_bf16 v[180:183], a[84:87], a[4:7], v[180:183]
ds_write_b64 v10, v[92:93] offset:13856
v_mfma_f32_16x16x32_bf16 v[184:187], a[84:87], a[8:11], v[184:187]
v_mfma_f32_16x16x32_bf16 v[188:191], a[84:87], a[12:15], v[188:191]
s_waitcnt vmcnt(20) lgkmcnt(3)
buffer_load_dwordx4 a[188:191], v15, s[24:27], s40 offen offset:3072
v_mfma_f32_16x16x32_bf16 v[192:195], a[88:91], a[16:19], v[192:195]
ds_read_b128 a[32:35], v8 offset:2336
ds_read_b128 a[36:39], v8 offset:6944
v_mfma_f32_16x16x32_bf16 v[196:199], a[88:91], a[20:23], v[196:199]
ds_read_b128 a[40:43], v8 offset:11552
ds_read_b128 a[44:47], v8 offset:16160
v_mfma_f32_16x16x32_bf16 v[200:203], a[88:91], a[24:27], v[200:203]
v_fmac_f32 v208, s8, v144
v_fmac_f32_e64 v209, s8, v145
v_mfma_f32_16x16x32_bf16 v[92:95], v[56:59], v[84:87], 0
v_cvt_pk_bf16_f32 v88, v88, v89
v_cvt_pk_bf16_f32 v89, v90, v91
v_mfma_f32_16x16x32_bf16 v[204:207], a[88:91], a[28:31], v[204:207]
s_add_u32 s40, s40, 16384
buffer_load_dwordx4 a[192:195], v12, s[24:27], s40 offen offset:0
v_fmac_f32_e64 v192, s8, v128
v_mfma_f32_16x16x32_bf16 v[220:223], a[96:99], a[28:31], v[220:223]
ds_write_b64 v10, v[88:89] offset:16160
v_mfma_f32_16x16x32_bf16 v[216:219], a[96:99], a[24:27], v[216:219]
v_fmac_f32 v193, s8, v129
v_fmac_f32 v194, s8, v130
v_mfma_f32_16x16x32_bf16 v[212:215], a[96:99], a[20:23], v[212:215]
v_fmac_f32 v195, s8, v131
v_fmac_f32 v196, s8, v132
v_mfma_f32_16x16x32_bf16 v[208:211], a[96:99], a[16:19], v[208:211]
buffer_load_dwordx4 a[196:199], v12, s[24:27], s40 offen offset:1024
v_fmac_f32_e64 v197, s8, v133
v_mfma_f32_16x16x32_bf16 v[224:227], a[100:103], a[16:19], v[224:227]
v_fmac_f32 v198, s8, v134
v_fmac_f32 v199, s8, v135
v_mfma_f32_16x16x32_bf16 v[88:91], v[60:63], v[76:79], 0
v_cvt_pk_bf16_f32 v92, v92, v93
v_cvt_pk_bf16_f32 v93, v94, v95
v_mfma_f32_16x16x32_bf16 v[228:231], a[100:103], a[20:23], v[228:231]
ds_write_b64 v10, v[92:93] offset:18464
v_mfma_f32_16x16x32_bf16 v[232:235], a[100:103], a[24:27], v[232:235]
v_fmac_f32 v200, s8, v136
v_fmac_f32 v201, s8, v137
v_mfma_f32_16x16x32_bf16 v[236:239], a[100:103], a[28:31], v[236:239]
buffer_load_dwordx4 a[200:203], v12, s[24:27], s40 offen offset:2048
v_fmac_f32_e64 v202, s8, v138
v_mfma_f32_16x16x32_bf16 v[252:255], a[112:115], a[28:31], v[252:255]
v_fmac_f32 v203, s8, v139
v_fmac_f32 v204, s8, v140
v_mfma_f32_16x16x32_bf16 v[248:251], a[112:115], a[24:27], v[248:251]
v_fmac_f32 v205, s8, v141
v_fmac_f32 v206, s8, v142
v_mfma_f32_16x16x32_bf16 v[244:247], a[112:115], a[20:23], v[244:247]
v_fmac_f32 v207, s8, v143
v_fmac_f32 v210, s8, v146
v_mfma_f32_16x16x32_bf16 v[92:95], v[60:63], v[80:83], 0
buffer_load_dwordx4 a[204:207], v12, s[24:27], s40 offen offset:3072
v_cvt_pk_bf16_f32 v88, v88, v89
v_mfma_f32_16x16x32_bf16 v[240:243], a[112:115], a[16:19], v[240:243]
s_waitcnt vmcnt(21) lgkmcnt(2)
v_cvt_pk_bf16_f32 v89, v90, v91
v_fmac_f32 v211, s8, v147
v_mfma_f32_16x16x32_bf16 v[192:195], a[132:135], a[32:35], v[192:195]
ds_read_b128 a[48:51], v8 offset:2400
ds_read_b128 a[52:55], v8 offset:7008
v_mfma_f32_16x16x32_bf16 v[196:199], a[132:135], a[36:39], v[196:199]
ds_read_b128 a[56:59], v8 offset:11616
ds_read_b128 a[60:63], v8 offset:16224
v_mfma_f32_16x16x32_bf16 v[200:203], a[132:135], a[40:43], v[200:203]
buffer_load_dwordx4 a[208:211], v13, s[24:27], s40 offen offset:0
v_fmac_f32_e64 v212, s8, v148
v_mfma_f32_16x16x32_bf16 v[204:207], a[132:135], a[44:47], v[204:207]
ds_write_b64 v10, v[88:89] offset:13888
v_mfma_f32_16x16x32_bf16 v[220:223], a[152:155], a[44:47], v[220:223]
v_fmac_f32 v213, s8, v149
v_fmac_f32 v214, s8, v150
v_mfma_f32_16x16x32_bf16 v[88:91], v[60:63], v[84:87], 0
v_cvt_pk_bf16_f32 v92, v92, v93
v_cvt_pk_bf16_f32 v93, v94, v95
v_mfma_f32_16x16x32_bf16 v[216:219], a[152:155], a[40:43], v[216:219]
ds_write_b64 v10, v[92:93] offset:16192
v_mfma_f32_16x16x32_bf16 v[212:215], a[152:155], a[36:39], v[212:215]
buffer_load_dwordx4 a[212:215], v13, s[24:27], s40 offen offset:1024
v_fmac_f32_e64 v220, s8, v156
v_mfma_f32_16x16x32_bf16 v[208:211], a[152:155], a[32:35], v[208:211]
v_fmac_f32 v221, s8, v157
v_fmac_f32 v222, s8, v158
v_mfma_f32_16x16x32_bf16 v[224:227], a[104:107], a[32:35], v[224:227]
v_fmac_f32 v216, s8, v152
v_fmac_f32 v217, s8, v153
v_mfma_f32_16x16x32_bf16 v[228:231], a[104:107], a[36:39], v[228:231]
v_fmac_f32 v215, s8, v151
v_fmac_f32 v218, s8, v154
v_mfma_f32_16x16x32_bf16 v[232:235], a[104:107], a[40:43], v[232:235]
buffer_load_dwordx4 a[216:219], v13, s[24:27], s40 offen offset:2048
v_fmac_f32_e64 v219, s8, v155
v_mfma_f32_16x16x32_bf16 v[92:95], v[64:67], v[76:79], 0
v_cvt_pk_bf16_f32 v88, v88, v89
v_cvt_pk_bf16_f32 v89, v90, v91
v_mfma_f32_16x16x32_bf16 v[236:239], a[104:107], a[44:47], v[236:239]
ds_write_b64 v10, v[88:89] offset:18496
v_mfma_f32_16x16x32_bf16 v[252:255], a[108:111], a[44:47], v[252:255]
v_fmac_f32 v223, s8, v159
v_fmac_f32 v224, s8, v160
v_mfma_f32_16x16x32_bf16 v[248:251], a[108:111], a[40:43], v[248:251]
v_fmac_f32 v225, s8, v161
v_fmac_f32 v226, s8, v162
v_mfma_f32_16x16x32_bf16 v[244:247], a[108:111], a[36:39], v[244:247]
buffer_load_dwordx4 a[220:223], v13, s[24:27], s40 offen offset:3072
v_fmac_f32_e64 v227, s8, v163
v_mfma_f32_16x16x32_bf16 v[240:243], a[108:111], a[32:35], v[240:243]
s_waitcnt vmcnt(21) lgkmcnt(3)
v_fmac_f32 v228, s8, v164
v_fmac_f32_e64 v229, s8, v165
v_mfma_f32_16x16x32_bf16 v[192:195], a[116:119], a[48:51], v[192:195]
ds_read_b128 a[0:3], v8 offset:2464
ds_read_b128 a[4:7], v8 offset:7072
v_mfma_f32_16x16x32_bf16 v[88:91], v[64:67], v[80:83], 0
ds_read_b128 a[8:11], v8 offset:11680
ds_read_b128 a[12:15], v8 offset:16288
v_mfma_f32_16x16x32_bf16 v[196:199], a[116:119], a[52:55], v[196:199]
buffer_load_dwordx4 a[224:227], v14, s[24:27], s40 offen offset:0
v_cvt_pk_bf16_f32 v92, v92, v93
v_mfma_f32_16x16x32_bf16 v[200:203], a[116:119], a[56:59], v[200:203]
v_cvt_pk_bf16_f32 v93, v94, v95
v_fmac_f32_e64 v230, s8, v166
v_mfma_f32_16x16x32_bf16 v[204:207], a[116:119], a[60:63], v[204:207]
ds_write_b64 v10, v[92:93] offset:13920
v_mfma_f32_16x16x32_bf16 v[220:223], a[120:123], a[60:63], v[220:223]
v_fmac_f32 v231, s8, v167
v_fmac_f32 v232, s8, v168
v_mfma_f32_16x16x32_bf16 v[216:219], a[120:123], a[56:59], v[216:219]
v_fmac_f32 v233, s8, v169
v_fmac_f32 v234, s8, v170
v_mfma_f32_16x16x32_bf16 v[212:215], a[120:123], a[52:55], v[212:215]
buffer_load_dwordx4 a[228:231], v14, s[24:27], s40 offen offset:1024
v_fmac_f32_e64 v235, s8, v171
v_mfma_f32_16x16x32_bf16 v[92:95], v[64:67], v[84:87], 0
v_cvt_pk_bf16_f32 v88, v88, v89
v_cvt_pk_bf16_f32 v89, v90, v91
v_mfma_f32_16x16x32_bf16 v[208:211], a[120:123], a[48:51], v[208:211]
ds_write_b64 v10, v[88:89] offset:16224
v_mfma_f32_16x16x32_bf16 v[224:227], a[124:127], a[48:51], v[224:227]
v_fmac_f32 v236, s8, v172
v_fmac_f32 v237, s8, v173
v_mfma_f32_16x16x32_bf16 v[228:231], a[124:127], a[52:55], v[228:231]
buffer_load_dwordx4 a[232:235], v14, s[24:27], s40 offen offset:2048
v_fmac_f32_e64 v240, s8, v176
v_mfma_f32_16x16x32_bf16 v[232:235], a[124:127], a[56:59], v[232:235]
v_fmac_f32 v241, s8, v177
v_fmac_f32 v242, s8, v178
v_mfma_f32_16x16x32_bf16 v[236:239], a[124:127], a[60:63], v[236:239]
v_fmac_f32 v243, s8, v179
v_fmac_f32 v244, s8, v180
v_mfma_f32_16x16x32_bf16 v[252:255], a[128:131], a[60:63], v[252:255]
v_fmac_f32 v245, s8, v181
v_fmac_f32 v246, s8, v182
v_mfma_f32_16x16x32_bf16 v[88:91], v[68:71], v[76:79], 0
buffer_load_dwordx4 a[236:239], v14, s[24:27], s40 offen offset:3072
v_cvt_pk_bf16_f32 v92, v92, v93
v_mfma_f32_16x16x32_bf16 v[248:251], a[128:131], a[56:59], v[248:251]
v_cvt_pk_bf16_f32 v93, v94, v95
v_fmac_f32_e64 v238, s8, v174
v_mfma_f32_16x16x32_bf16 v[244:247], a[128:131], a[52:55], v[244:247]
ds_write_b64 v10, v[92:93] offset:18528
v_mfma_f32_16x16x32_bf16 v[240:243], a[128:131], a[48:51], v[240:243]
s_waitcnt vmcnt(21) lgkmcnt(3)
v_fmac_f32 v239, s8, v175
v_fmac_f32_e64 v252, s8, v188
v_mfma_f32_16x16x32_bf16 v[192:195], a[136:139], a[0:3], v[192:195]
ds_read_b128 a[16:19], v9 offset:0
ds_read_b128 a[20:23], v9 offset:4608
v_mfma_f32_16x16x32_bf16 v[196:199], a[136:139], a[4:7], v[196:199]
buffer_load_dwordx4 a[240:243], v15, s[24:27], s40 offen offset:0
ds_read_b128 a[24:27], v9 offset:9216
v_mfma_f32_16x16x32_bf16 v[200:203], a[136:139], a[8:11], v[200:203]
ds_read_b128 a[28:31], v9 offset:13824
v_fmac_f32_e64 v247, s8, v183
v_mfma_f32_16x16x32_bf16 v[92:95], v[68:71], v[80:83], 0
v_cvt_pk_bf16_f32 v88, v88, v89
v_cvt_pk_bf16_f32 v89, v90, v91
v_mfma_f32_16x16x32_bf16 v[204:207], a[136:139], a[12:15], v[204:207]
ds_write_b64 v11, v[88:89] offset:0
v_mfma_f32_16x16x32_bf16 v[220:223], a[140:143], a[12:15], v[220:223]
buffer_load_dwordx4 a[244:247], v15, s[24:27], s40 offen offset:1024
v_fmac_f32_e64 v248, s8, v184
v_mfma_f32_16x16x32_bf16 v[216:219], a[140:143], a[8:11], v[216:219]
v_fmac_f32 v249, s8, v185
v_fmac_f32 v250, s8, v186
v_mfma_f32_16x16x32_bf16 v[212:215], a[140:143], a[4:7], v[212:215]
v_fmac_f32 v251, s8, v187
v_fmac_f32 v253, s8, v189
v_mfma_f32_16x16x32_bf16 v[208:211], a[140:143], a[0:3], v[208:211]
v_fmac_f32 v254, s8, v190
v_fmac_f32 v255, s8, v191
v_mfma_f32_16x16x32_bf16 v[224:227], a[144:147], a[0:3], v[224:227]
v_mfma_f32_16x16x32_bf16 v[88:91], v[68:71], v[84:87], 0
buffer_load_dwordx4 a[248:251], v15, s[24:27], s40 offen offset:2048
v_cvt_pk_bf16_f32 v92, v92, v93
v_mfma_f32_16x16x32_bf16 v[228:231], a[144:147], a[4:7], v[228:231]
v_cvt_pk_bf16_f32 v93, v94, v95
v_mfma_f32_16x16x32_bf16 v[232:235], a[144:147], a[8:11], v[232:235]
ds_write_b64 v11, v[92:93] offset:2304
v_mfma_f32_16x16x32_bf16 v[236:239], a[144:147], a[12:15], v[236:239]
v_mfma_f32_16x16x32_bf16 v[252:255], a[148:151], a[12:15], v[252:255]
buffer_load_dwordx4 a[252:255], v15, s[24:27], s40 offen offset:3072
v_mfma_f32_16x16x32_bf16 v[248:251], a[148:151], a[8:11], v[248:251]
v_mfma_f32_16x16x32_bf16 v[244:247], a[148:151], a[4:7], v[244:247]
v_mfma_f32_16x16x32_bf16 v[92:95], v[72:75], v[76:79], 0
v_cvt_pk_bf16_f32 v88, v88, v89
v_cvt_pk_bf16_f32 v89, v90, v91
v_mfma_f32_16x16x32_bf16 v[240:243], a[148:151], a[0:3], v[240:243]
s_waitcnt vmcnt(21) lgkmcnt(2)
s_add_u32 s40, s40, 16384
buffer_load_dwordx4 a[72:75], v12, s[24:27], s40 offen offset:0
v_mfma_f32_16x16x32_bf16 v[192:195], a[156:159], a[16:19], v[192:195]
ds_read_b128 a[32:35], v8 offset:0
ds_read_b128 a[36:39], v8 offset:4608
v_mfma_f32_16x16x32_bf16 v[196:199], a[156:159], a[20:23], v[196:199]
ds_read_b128 a[40:43], v8 offset:9216
ds_read_b128 a[44:47], v8 offset:13824
v_mfma_f32_16x16x32_bf16 v[200:203], a[156:159], a[24:27], v[200:203]
ds_write_b64 v11, v[88:89] offset:4608
v_mfma_f32_16x16x32_bf16 v[204:207], a[156:159], a[28:31], v[204:207]
v_mfma_f32_16x16x32_bf16 v[220:223], a[160:163], a[28:31], v[220:223]
buffer_load_dwordx4 a[64:67], v12, s[24:27], s40 offen offset:1024
v_mfma_f32_16x16x32_bf16 v[88:91], v[72:75], v[80:83], 0
v_cvt_pk_bf16_f32 v92, v92, v93
v_cvt_pk_bf16_f32 v93, v94, v95
v_mfma_f32_16x16x32_bf16 v[216:219], a[160:163], a[24:27], v[216:219]
ds_write_b64 v11, v[92:93] offset:6912
v_mfma_f32_16x16x32_bf16 v[212:215], a[160:163], a[20:23], v[212:215]
v_mfma_f32_16x16x32_bf16 v[208:211], a[160:163], a[16:19], v[208:211]
buffer_load_dwordx4 a[68:71], v12, s[24:27], s40 offen offset:2048
v_mfma_f32_16x16x32_bf16 v[224:227], a[164:167], a[16:19], v[224:227]
v_mfma_f32_16x16x32_bf16 v[228:231], a[164:167], a[20:23], v[228:231]
v_mfma_f32_16x16x32_bf16 v[232:235], a[164:167], a[24:27], v[232:235]
v_mfma_f32_16x16x32_bf16 v[92:95], v[72:75], v[84:87], 0
v_cvt_pk_bf16_f32 v88, v88, v89
v_cvt_pk_bf16_f32 v89, v90, v91
v_mfma_f32_16x16x32_bf16 v[236:239], a[164:167], a[28:31], v[236:239]
buffer_load_dwordx4 a[76:79], v12, s[24:27], s40 offen offset:3072
v_mfma_f32_16x16x32_bf16 v[252:255], a[168:171], a[28:31], v[252:255]
ds_write_b64 v11, v[88:89] offset:9216
v_mfma_f32_16x16x32_bf16 v[248:251], a[168:171], a[24:27], v[248:251]
v_mfma_f32_16x16x32_bf16 v[244:247], a[168:171], a[20:23], v[244:247]
v_mfma_f32_16x16x32_bf16 v[240:243], a[168:171], a[16:19], v[240:243]
s_waitcnt vmcnt(21) lgkmcnt(3)
buffer_load_dwordx4 a[80:83], v13, s[24:27], s40 offen offset:0
v_mfma_f32_16x16x32_bf16 v[192:195], a[172:175], a[32:35], v[192:195]
ds_read_b128 a[48:51], v8 offset:64
ds_read_b128 a[52:55], v8 offset:4672
v_mfma_f32_16x16x32_bf16 v[196:199], a[172:175], a[36:39], v[196:199]
ds_read_b128 a[56:59], v8 offset:9280
ds_read_b128 a[60:63], v8 offset:13888
v_mfma_f32_16x16x32_bf16 v[200:203], a[172:175], a[40:43], v[200:203]
v_cvt_pk_bf16_f32 v92, v92, v93
v_cvt_pk_bf16_f32 v93, v94, v95
v_mfma_f32_16x16x32_bf16 v[204:207], a[172:175], a[44:47], v[204:207]
buffer_load_dwordx4 a[92:95], v13, s[24:27], s40 offen offset:1024
v_mfma_f32_16x16x32_bf16 v[220:223], a[176:179], a[44:47], v[220:223]
ds_write_b64 v11, v[92:93] offset:11520
v_mfma_f32_16x16x32_bf16 v[216:219], a[176:179], a[40:43], v[216:219]
v_mfma_f32_16x16x32_bf16 v[212:215], a[176:179], a[36:39], v[212:215]
v_mfma_f32_16x16x32_bf16 v[208:211], a[176:179], a[32:35], v[208:211]
v_mfma_f32_16x16x32_bf16 v[224:227], a[180:183], a[32:35], v[224:227]
buffer_load_dwordx4 a[84:87], v13, s[24:27], s40 offen offset:2048
v_mfma_f32_16x16x32_bf16 v[228:231], a[180:183], a[36:39], v[228:231]
v_mfma_f32_16x16x32_bf16 v[232:235], a[180:183], a[40:43], v[232:235]
v_mfma_f32_16x16x32_bf16 v[236:239], a[180:183], a[44:47], v[236:239]
v_mfma_f32_16x16x32_bf16 v[252:255], a[184:187], a[44:47], v[252:255]
buffer_load_dwordx4 a[88:91], v13, s[24:27], s40 offen offset:3072
v_mfma_f32_16x16x32_bf16 v[248:251], a[184:187], a[40:43], v[248:251]
v_mfma_f32_16x16x32_bf16 v[244:247], a[184:187], a[36:39], v[244:247]
v_mfma_f32_16x16x32_bf16 v[240:243], a[184:187], a[32:35], v[240:243]
s_waitcnt vmcnt(21) lgkmcnt(1)
v_mfma_f32_16x16x32_bf16 v[192:195], a[188:191], a[48:51], v[192:195]
ds_read_b128 a[0:3], v8 offset:128
ds_read_b128 a[4:7], v8 offset:4736
v_mfma_f32_16x16x32_bf16 v[196:199], a[188:191], a[52:55], v[196:199]
buffer_load_dwordx4 a[96:99], v14, s[24:27], s40 offen offset:0
ds_read_b128 a[8:11], v8 offset:9344
v_mfma_f32_16x16x32_bf16 v[200:203], a[188:191], a[56:59], v[200:203]
ds_read_b128 a[12:15], v8 offset:13952
v_mfma_f32_16x16x32_bf16 v[204:207], a[188:191], a[60:63], v[204:207]
v_mfma_f32_16x16x32_bf16 v[220:223], a[192:195], a[60:63], v[220:223]
v_mfma_f32_16x16x32_bf16 v[216:219], a[192:195], a[56:59], v[216:219]
buffer_load_dwordx4 a[100:103], v14, s[24:27], s40 offen offset:1024
v_mfma_f32_16x16x32_bf16 v[212:215], a[192:195], a[52:55], v[212:215]
v_mfma_f32_16x16x32_bf16 v[208:211], a[192:195], a[48:51], v[208:211]
v_mfma_f32_16x16x32_bf16 v[224:227], a[196:199], a[48:51], v[224:227]
v_mfma_f32_16x16x32_bf16 v[228:231], a[196:199], a[52:55], v[228:231]
v_mfma_f32_16x16x32_bf16 v[232:235], a[196:199], a[56:59], v[232:235]
buffer_load_dwordx4 a[112:115], v14, s[24:27], s40 offen offset:2048
v_mfma_f32_16x16x32_bf16 v[236:239], a[196:199], a[60:63], v[236:239]
v_mfma_f32_16x16x32_bf16 v[252:255], a[200:203], a[60:63], v[252:255]
v_mfma_f32_16x16x32_bf16 v[248:251], a[200:203], a[56:59], v[248:251]
v_mfma_f32_16x16x32_bf16 v[244:247], a[200:203], a[52:55], v[244:247]
buffer_load_dwordx4 a[132:135], v14, s[24:27], s40 offen offset:3072
v_mfma_f32_16x16x32_bf16 v[240:243], a[200:203], a[48:51], v[240:243]
s_waitcnt vmcnt(21) lgkmcnt(0)
v_mfma_f32_16x16x32_bf16 v[192:195], a[204:207], a[0:3], v[192:195]
ds_read_b128 a[16:19], v8 offset:192
ds_read_b128 a[20:23], v8 offset:4800
v_mfma_f32_16x16x32_bf16 v[196:199], a[204:207], a[4:7], v[196:199]
ds_read_b128 a[24:27], v8 offset:9408
ds_read_b128 a[28:31], v8 offset:14016
v_mfma_f32_16x16x32_bf16 v[200:203], a[204:207], a[8:11], v[200:203]
buffer_load_dwordx4 a[152:155], v15, s[24:27], s40 offen offset:0
v_mfma_f32_16x16x32_bf16 v[204:207], a[204:207], a[12:15], v[204:207]
v_mfma_f32_16x16x32_bf16 v[220:223], a[208:211], a[12:15], v[220:223]
v_mfma_f32_16x16x32_bf16 v[216:219], a[208:211], a[8:11], v[216:219]
v_mfma_f32_16x16x32_bf16 v[212:215], a[208:211], a[4:7], v[212:215]
v_mfma_f32_16x16x32_bf16 v[208:211], a[208:211], a[0:3], v[208:211]
buffer_load_dwordx4 a[104:107], v15, s[24:27], s40 offen offset:1024
v_mfma_f32_16x16x32_bf16 v[224:227], a[212:215], a[0:3], v[224:227]
v_mfma_f32_16x16x32_bf16 v[228:231], a[212:215], a[4:7], v[228:231]
v_mfma_f32_16x16x32_bf16 v[232:235], a[212:215], a[8:11], v[232:235]
v_mfma_f32_16x16x32_bf16 v[236:239], a[212:215], a[12:15], v[236:239]
buffer_load_dwordx4 a[108:111], v15, s[24:27], s40 offen offset:2048
v_mfma_f32_16x16x32_bf16 v[252:255], a[216:219], a[12:15], v[252:255]
v_mfma_f32_16x16x32_bf16 v[248:251], a[216:219], a[8:11], v[248:251]
v_mfma_f32_16x16x32_bf16 v[244:247], a[216:219], a[4:7], v[244:247]
v_mfma_f32_16x16x32_bf16 v[240:243], a[216:219], a[0:3], v[240:243]
s_waitcnt vmcnt(20) lgkmcnt(0)
v_mfma_f32_16x16x32_bf16 v[192:195], a[220:223], a[16:19], v[192:195]
buffer_load_dwordx4 a[116:119], v15, s[24:27], s40 offen offset:3072
v_mfma_f32_16x16x32_bf16 v[196:199], a[220:223], a[20:23], v[196:199]
s_barrier
v_mfma_f32_16x16x32_bf16 v[200:203], a[220:223], a[24:27], v[200:203]
ds_read_b128 a[32:35], v2 offset:2272
ds_read_b128 a[36:39], v2 offset:6880
v_mfma_f32_16x16x32_bf16 v[204:207], a[220:223], a[28:31], v[204:207]
ds_read_b128 a[40:43], v2 offset:11488
ds_read_b128 a[44:47], v2 offset:16096
v_mfma_f32_16x16x32_bf16 v[220:223], a[224:227], a[28:31], v[220:223]
v_mfma_f32_16x16x32_bf16 v[216:219], a[224:227], a[24:27], v[216:219]
s_add_u32 s40, s40, 16384
buffer_load_dwordx4 a[120:123], v12, s[24:27], s40 offen offset:0
v_mfma_f32_16x16x32_bf16 v[212:215], a[224:227], a[20:23], v[212:215]
v_mfma_f32_16x16x32_bf16 v[208:211], a[224:227], a[16:19], v[208:211]
v_mfma_f32_16x16x32_bf16 v[224:227], a[228:231], a[16:19], v[224:227]
v_mfma_f32_16x16x32_bf16 v[228:231], a[228:231], a[20:23], v[228:231]
buffer_load_dwordx4 a[124:127], v12, s[24:27], s40 offen offset:1024
v_mfma_f32_16x16x32_bf16 v[232:235], a[228:231], a[24:27], v[232:235]
v_mfma_f32_16x16x32_bf16 v[236:239], a[228:231], a[28:31], v[236:239]
v_mfma_f32_16x16x32_bf16 v[252:255], a[232:235], a[28:31], v[252:255]
v_mfma_f32_16x16x32_bf16 v[248:251], a[232:235], a[24:27], v[248:251]
v_mfma_f32_16x16x32_bf16 v[244:247], a[232:235], a[20:23], v[244:247]
buffer_load_dwordx4 a[128:131], v12, s[24:27], s40 offen offset:2048
v_mfma_f32_16x16x32_bf16 v[240:243], a[232:235], a[16:19], v[240:243]
s_waitcnt vmcnt(21) lgkmcnt(0)
v_mfma_f32_16x16x32_bf16 v[96:99], a[236:239], a[32:35], v[96:99]
ds_read_b128 a[48:51], v2 offset:2336
ds_read_b128 a[52:55], v2 offset:6944
v_mfma_f32_16x16x32_bf16 v[100:103], a[236:239], a[36:39], v[100:103]
ds_read_b128 a[56:59], v2 offset:11552
ds_read_b128 a[60:63], v2 offset:16160
v_mfma_f32_16x16x32_bf16 v[104:107], a[236:239], a[40:43], v[104:107]
buffer_load_dwordx4 a[136:139], v12, s[24:27], s40 offen offset:3072
s_xor_b32 s38, s3, 0
v_mfma_f32_16x16x32_bf16 v[108:111], a[236:239], a[44:47], v[108:111]
s_lshl_b32 s36, s38, 12
s_add_u32 s36, s36, 145024
v_mfma_f32_16x16x32_bf16 v[140:143], a[240:243], a[44:47], v[140:143]
s_cmp_eq_u32 s38, 0
s_cmov_b32 s36, 41536
s_xor_b32 s38, s3, 1
v_mfma_f32_16x16x32_bf16 v[136:139], a[240:243], a[40:43], v[136:139]
s_lshl_b32 s37, s38, 12
s_add_u32 s37, s37, 145024
v_mfma_f32_16x16x32_bf16 v[132:135], a[240:243], a[36:39], v[132:135]
s_cmp_eq_u32 s38, 0
s_cmov_b32 s37, 41536
v_lshlrev_b32 v77, 4, v1
v_mfma_f32_16x16x32_bf16 v[128:131], a[240:243], a[32:35], v[128:131]
buffer_load_dwordx4 a[140:143], v13, s[24:27], s40 offen offset:0
v_add_u32_e64 v76, s36, v77
v_mfma_f32_16x16x32_bf16 v[144:147], a[244:247], a[32:35], v[144:147]
v_add_u32 v77, s37, v77
v_and_b32 v78, 1, v1
v_mfma_f32_16x16x32_bf16 v[148:151], a[244:247], a[36:39], v[148:151]
v_bfe_u32 v79, v1, 1, 3
v_lshl_add_u32 v78, v78, 4, v79
v_mfma_f32_16x16x32_bf16 v[152:155], a[244:247], a[40:43], v[152:155]
v_mul_u32_u24 v78, 160, v78
v_lshrrev_b32_e64 v79, 4, v1
v_mfma_f32_16x16x32_bf16 v[156:159], a[244:247], a[44:47], v[156:159]
s_waitcnt vmcnt(20) lgkmcnt(0)
buffer_load_dwordx4 a[144:147], v13, s[24:27], s40 offen offset:1024
s_mul_i32 s38, s13, 10240
v_mfma_f32_16x16x32_bf16 v[96:99], a[248:251], a[48:51], v[96:99]
ds_read_b128 a[0:3], v2 offset:2400
ds_read_b128 a[4:7], v2 offset:7008
v_mfma_f32_16x16x32_bf16 v[100:103], a[248:251], a[52:55], v[100:103]
ds_read_b128 a[8:11], v2 offset:11616
ds_read_b128 a[12:15], v2 offset:16224
v_mfma_f32_16x16x32_bf16 v[104:107], a[248:251], a[56:59], v[104:107]
s_lshl_b32 s36, s3, 5
s_add_u32 s37, s36, 118400
v_mfma_f32_16x16x32_bf16 v[108:111], a[248:251], a[60:63], v[108:111]
buffer_load_dwordx4 a[148:151], v13, s[24:27], s40 offen offset:2048
s_sub_u32 s37, s37, s38
v_mfma_f32_16x16x32_bf16 v[140:143], a[252:255], a[60:63], v[140:143]
s_add_u32 s38, s38, 108160
s_add_u32 s36, s36, s38
v_mfma_f32_16x16x32_bf16 v[136:139], a[252:255], a[56:59], v[136:139]
v_lshl_add_u32 v80, v79, 3, v78
v_add_u32_e64 v16, s36, v80
v_mfma_f32_16x16x32_bf16 v[132:135], a[252:255], a[52:55], v[132:135]
v_add_u32 v17, s37, v80
v_and_b32 v80, 1, v79
v_mfma_f32_16x16x32_bf16 v[128:131], a[252:255], a[48:51], v[128:131]
v_lshl_add_u32 v18, v80, 3, v78
v_lshrrev_b32_e64 v80, 1, v79
v_mfma_f32_16x16x32_bf16 v[144:147], a[72:75], a[48:51], v[144:147]
buffer_load_dwordx4 a[156:159], v13, s[24:27], s40 offen offset:3072
v_mul_u32_u24 v80, 1280, v80
v_mfma_f32_16x16x32_bf16 v[148:151], a[72:75], a[52:55], v[148:151]
s_lshr_b32 s37, s3, 1
s_lshl_b32 s37, s37, 4
v_mfma_f32_16x16x32_bf16 v[152:155], a[72:75], a[56:59], v[152:155]
s_add_u32 s36, s38, s37
s_add_u32 s36, s36, 20608
v_mfma_f32_16x16x32_bf16 v[156:159], a[72:75], a[60:63], v[156:159]
s_waitcnt vmcnt(20) lgkmcnt(0)
v_add3_u32 v18, v18, v80, s36
v_and_b32_e64 v78, 15, v1
v_mfma_f32_16x16x32_bf16 v[96:99], a[64:67], a[0:3], v[96:99]
buffer_load_dwordx4 a[160:163], v14, s[24:27], s40 offen offset:0
ds_read_b128 a[16:19], v2 offset:2464
v_mfma_f32_16x16x32_bf16 v[100:103], a[64:67], a[4:7], v[100:103]
ds_read_b128 a[20:23], v2 offset:7072
ds_read_b128 a[24:27], v2 offset:11680
v_mfma_f32_16x16x32_bf16 v[104:107], a[64:67], a[8:11], v[104:107]
ds_read_b128 a[28:31], v2 offset:16288
v_mul_u32_u24 v80, 160, v78
v_mfma_f32_16x16x32_bf16 v[108:111], a[64:67], a[12:15], v[108:111]
v_mul_u32_u24 v78, 288, v78
v_lshl_add_u32 v80, v79, 4, v80
v_mfma_f32_16x16x32_bf16 v[140:143], a[68:71], a[12:15], v[140:143]
v_and_b32 v19, 32, v1
v_sub_u32 v80, v80, v19
v_mfma_f32_16x16x32_bf16 v[136:139], a[68:71], a[8:11], v[136:139]
buffer_load_dwordx4 a[164:167], v14, s[24:27], s40 offen offset:1024
s_xor_b32 s36, s3, 0
v_mfma_f32_16x16x32_bf16 v[132:135], a[68:71], a[4:7], v[132:135]
s_and_b32 s37, s36, 2
s_add_u32 s36, s36, s37
v_mfma_f32_16x16x32_bf16 v[128:131], a[68:71], a[0:3], v[128:131]
s_mul_i32 s36, s36, 2560
s_add_u32 s36, s36, 108160
v_mfma_f32_16x16x32_bf16 v[144:147], a[76:79], a[0:3], v[144:147]
v_add_u32_e64 v92, s36, v80
s_xor_b32 s36, s3, 1
v_mfma_f32_16x16x32_bf16 v[148:151], a[76:79], a[4:7], v[148:151]
buffer_load_dwordx4 a[168:171], v14, s[24:27], s40 offen offset:2048
s_and_b32 s37, s36, 2
v_mfma_f32_16x16x32_bf16 v[152:155], a[76:79], a[8:11], v[152:155]
s_add_u32 s36, s36, s37
s_mul_i32 s36, s36, 2560
v_mfma_f32_16x16x32_bf16 v[156:159], a[76:79], a[12:15], v[156:159]
s_waitcnt vmcnt(20) lgkmcnt(0)
s_add_u32 s36, s36, 108160
v_add_u32 v93, s36, v80
v_mfma_f32_16x16x32_bf16 v[96:99], a[80:83], a[16:19], v[96:99]
ds_read_b128 a[32:35], v3 offset:0
ds_read_b128 a[36:39], v3 offset:4608
v_mfma_f32_16x16x32_bf16 v[100:103], a[80:83], a[20:23], v[100:103]
ds_read_b128 a[40:43], v3 offset:9216
ds_read_b128 a[44:47], v3 offset:13824
v_mfma_f32_16x16x32_bf16 v[104:107], a[80:83], a[24:27], v[104:107]
buffer_load_dwordx4 a[172:175], v14, s[24:27], s40 offen offset:3072
v_lshlrev_b32_e64 v78, 2, v78
v_mfma_f32_16x16x32_bf16 v[108:111], a[80:83], a[28:31], v[108:111]
v_lshl_add_u32 v11, v79, 3, v78
v_and_b32_e64 v78, 15, v1
v_mfma_f32_16x16x32_bf16 v[140:143], a[92:95], a[28:31], v[140:143]
v_mul_u32_u24 v80, 4608, v79
v_lshl_add_u32 v10, v78, 3, v80
v_mfma_f32_16x16x32_bf16 v[136:139], a[92:95], a[24:27], v[136:139]
v_and_b32 v78, 3, v1
v_lshrrev_b32 v79, 2, v1
v_mfma_f32_16x16x32_bf16 v[132:135], a[92:95], a[20:23], v[132:135]
buffer_load_dwordx4 a[176:179], v15, s[24:27], s40 offen offset:0
v_mul_u32_u24 v80, 1152, v79
v_mfma_f32_16x16x32_bf16 v[128:131], a[92:95], a[16:19], v[128:131]
v_lshl_add_u32 v11, v78, 3, v80
v_lshl_add_u32 v78, v78, 4, v79
v_mfma_f32_16x16x32_bf16 v[144:147], a[84:87], a[16:19], v[144:147]
v_lshlrev_b32 v6, 2, v78
v_fmac_f32 v136, s9, v200
v_mfma_f32_16x16x32_bf16 v[148:151], a[84:87], a[20:23], v[148:151]
v_fmac_f32 v132, s9, v196
v_fmac_f32 v133, s9, v197
v_mfma_f32_16x16x32_bf16 v[152:155], a[84:87], a[24:27], v[152:155]
buffer_load_dwordx4 a[180:183], v15, s[24:27], s40 offen offset:1024
v_fmac_f32_e64 v128, s9, v192
v_mfma_f32_16x16x32_bf16 v[156:159], a[84:87], a[28:31], v[156:159]
s_waitcnt vmcnt(20) lgkmcnt(0)
v_fmac_f32 v129, s9, v193
v_fmac_f32_e64 v130, s9, v194
v_mfma_f32_16x16x32_bf16 v[96:99], a[88:91], a[32:35], v[96:99]
ds_read_b128 a[48:51], v2 offset:0
ds_read_b128 a[52:55], v2 offset:4608
v_mfma_f32_16x16x32_bf16 v[100:103], a[88:91], a[36:39], v[100:103]
ds_read_b128 a[56:59], v2 offset:9216
ds_read_b128 a[60:63], v2 offset:13824
v_mfma_f32_16x16x32_bf16 v[104:107], a[88:91], a[40:43], v[104:107]
v_fmac_f32 v131, s9, v195
v_fmac_f32 v134, s9, v198
v_mfma_f32_16x16x32_bf16 v[108:111], a[88:91], a[44:47], v[108:111]
buffer_load_dwordx4 a[184:187], v15, s[24:27], s40 offen offset:2048
v_fmac_f32_e64 v135, s9, v199
v_mfma_f32_16x16x32_bf16 v[140:143], a[96:99], a[44:47], v[140:143]
v_fmac_f32 v144, s9, v208
v_fmac_f32 v145, s9, v209
v_mfma_f32_16x16x32_bf16 v[136:139], a[96:99], a[40:43], v[136:139]
v_fmac_f32 v146, s9, v210
v_fmac_f32 v147, s9, v211
v_mfma_f32_16x16x32_bf16 v[132:135], a[96:99], a[36:39], v[132:135]
v_fmac_f32 v148, s9, v212
v_fmac_f32 v149, s9, v213
v_mfma_f32_16x16x32_bf16 v[128:131], a[96:99], a[32:35], v[128:131]
buffer_load_dwordx4 a[188:191], v15, s[24:27], s40 offen offset:3072
v_fmac_f32_e64 v140, s9, v204
v_mfma_f32_16x16x32_bf16 v[144:147], a[100:103], a[32:35], v[144:147]
v_fmac_f32 v137, s9, v201
v_fmac_f32 v138, s9, v202
v_mfma_f32_16x16x32_bf16 v[148:151], a[100:103], a[36:39], v[148:151]
v_fmac_f32 v139, s9, v203
v_fmac_f32 v141, s9, v205
v_mfma_f32_16x16x32_bf16 v[152:155], a[100:103], a[40:43], v[152:155]
v_fmac_f32 v142, s9, v206
v_fmac_f32_e64 v143, s9, v207
L_isl4:
s_cbranch_execz L_wret
v_mfma_f32_16x16x32_bf16 v[156:159], a[100:103], a[44:47], v[156:159]
s_waitcnt vmcnt(19) lgkmcnt(0)
v_fmac_f32 v160, s9, v224
v_fmac_f32_e64 v161, s9, v225
v_mfma_f32_16x16x32_bf16 v[96:99], a[112:115], a[48:51], v[96:99]
s_add_u32 s40, s40, 16384
buffer_load_dwordx4 a[192:195], v12, s[24:27], s40 offen offset:0
ds_read_b128 a[0:3], v2 offset:64
v_mfma_f32_16x16x32_bf16 v[100:103], a[112:115], a[52:55], v[100:103]
ds_read_b128 a[4:7], v2 offset:4672
ds_read_b128 a[8:11], v2 offset:9280
v_mfma_f32_16x16x32_bf16 v[104:107], a[112:115], a[56:59], v[104:107]
ds_read_b128 a[12:15], v2 offset:13888
v_fmac_f32_e64 v150, s9, v214
v_mfma_f32_16x16x32_bf16 v[108:111], a[112:115], a[60:63], v[108:111]
v_fmac_f32 v151, s9, v215
v_fmac_f32 v152, s9, v216
v_mfma_f32_16x16x32_bf16 v[140:143], a[132:135], a[60:63], v[140:143]
buffer_load_dwordx4 a[196:199], v12, s[24:27], s40 offen offset:1024
v_fmac_f32_e64 v153, s9, v217
v_mfma_f32_16x16x32_bf16 v[136:139], a[132:135], a[56:59], v[136:139]
v_fmac_f32 v154, s9, v218
v_fmac_f32 v155, s9, v219
v_mfma_f32_16x16x32_bf16 v[132:135], a[132:135], a[52:55], v[132:135]
v_fmac_f32 v156, s9, v220
v_fmac_f32 v157, s9, v221
v_mfma_f32_16x16x32_bf16 v[128:131], a[132:135], a[48:51], v[128:131]
v_fmac_f32 v158, s9, v222
v_fmac_f32 v159, s9, v223
v_mfma_f32_16x16x32_bf16 v[144:147], a[152:155], a[48:51], v[144:147]
buffer_load_dwordx4 a[200:203], v12, s[24:27], s40 offen offset:2048
v_fmac_f32_e64 v162, s9, v226
v_mfma_f32_16x16x32_bf16 v[148:151], a[152:155], a[52:55], v[148:151]
v_fmac_f32 v163, s9, v227
v_fmac_f32 v164, s9, v228
v_mfma_f32_16x16x32_bf16 v[152:155], a[152:155], a[56:59], v[152:155]
v_fmac_f32 v165, s9, v229
v_fmac_f32 v166, s9, v230
v_mfma_f32_16x16x32_bf16 v[156:159], a[152:155], a[60:63], v[156:159]
s_waitcnt vmcnt(19) lgkmcnt(0)
v_fmac_f32 v167, s9, v231
v_fmac_f32_e64 v168, s9, v232
v_mfma_f32_16x16x32_bf16 v[96:99], a[104:107], a[0:3], v[96:99]
ds_read_b128 a[16:19], v2 offset:128
ds_read_b128 a[20:23], v2 offset:4736
v_mfma_f32_16x16x32_bf16 v[100:103], a[104:107], a[4:7], v[100:103]
buffer_load_dwordx4 a[204:207], v12, s[24:27], s40 offen offset:3072
ds_read_b128 a[24:27], v2 offset:9344
v_mfma_f32_16x16x32_bf16 v[104:107], a[104:107], a[8:11], v[104:107]
ds_read_b128 a[28:31], v2 offset:13952
v_fmac_f32_e64 v169, s9, v233
v_mfma_f32_16x16x32_bf16 v[108:111], a[104:107], a[12:15], v[108:111]
v_fmac_f32 v170, s9, v234
v_fmac_f32 v171, s9, v235
v_mfma_f32_16x16x32_bf16 v[140:143], a[108:111], a[12:15], v[140:143]
v_fmac_f32 v172, s9, v236
v_fmac_f32 v173, s9, v237
v_mfma_f32_16x16x32_bf16 v[136:139], a[108:111], a[8:11], v[136:139]
buffer_load_dwordx4 a[208:211], v13, s[24:27], s40 offen offset:0
v_fmac_f32_e64 v174, s9, v238
v_mfma_f32_16x16x32_bf16 v[132:135], a[108:111], a[4:7], v[132:135]
v_fmac_f32 v175, s9, v239
v_fmac_f32 v176, s9, v240
v_mfma_f32_16x16x32_bf16 v[128:131], a[108:111], a[0:3], v[128:131]
v_fmac_f32 v177, s9, v241
v_fmac_f32 v178, s9, v242
v_mfma_f32_16x16x32_bf16 v[144:147], a[116:119], a[0:3], v[144:147]
v_fmac_f32 v179, s9, v243
v_fmac_f32 v180, s9, v244
v_mfma_f32_16x16x32_bf16 v[148:151], a[116:119], a[4:7], v[148:151]
v_fmac_f32 v96, s81, v112
v_fmac_f32 v97, s81, v113
v_mfma_f32_16x16x32_bf16 v[152:155], a[116:119], a[8:11], v[152:155]
buffer_load_dwordx4 a[212:215], v13, s[24:27], s40 offen offset:1024
v_fmac_f32_e64 v100, s81, v116
v_mfma_f32_16x16x32_bf16 v[156:159], a[116:119], a[12:15], v[156:159]
s_waitcnt vmcnt(19) lgkmcnt(0)
v_fmac_f32 v104, s81, v120
v_fmac_f32_e64 v105, s81, v121
v_mfma_f32_16x16x32_bf16 v[96:99], a[120:123], a[16:19], v[96:99]
ds_read_b128 a[32:35], v2 offset:192
ds_read_b128 a[36:39], v2 offset:4800
v_mfma_f32_16x16x32_bf16 v[100:103], a[120:123], a[20:23], v[100:103]
ds_read_b128 a[40:43], v2 offset:9408
ds_read_b128 a[44:47], v2 offset:14016
v_mfma_f32_16x16x32_bf16 v[104:107], a[120:123], a[24:27], v[104:107]
buffer_load_dwordx4 a[216:219], v13, s[24:27], s40 offen offset:2048
v_fmac_f32_e64 v181, s9, v245
v_mfma_f32_16x16x32_bf16 v[108:111], a[120:123], a[28:31], v[108:111]
v_fmac_f32 v98, s81, v114
v_fmac_f32 v99, s81, v115
v_mfma_f32_16x16x32_bf16 v[140:143], a[124:127], a[28:31], v[140:143]
v_fmac_f32 v101, s81, v117
v_fmac_f32 v102, s81, v118
v_mfma_f32_16x16x32_bf16 v[136:139], a[124:127], a[24:27], v[136:139]
v_fmac_f32 v103, s81, v119
v_fmac_f32 v106, s81, v122
v_mfma_f32_16x16x32_bf16 v[132:135], a[124:127], a[20:23], v[132:135]
buffer_load_dwordx4 a[220:223], v13, s[24:27], s40 offen offset:3072
v_fmac_f32_e64 v107, s81, v123
v_mfma_f32_16x16x32_bf16 v[128:131], a[124:127], a[16:19], v[128:131]
v_fmac_f32 v108, s81, v124
v_fmac_f32 v109, s81, v125
v_mfma_f32_16x16x32_bf16 v[144:147], a[128:131], a[16:19], v[144:147]
v_fmac_f32 v110, s81, v126
v_fmac_f32 v111, s81, v127
v_mfma_f32_16x16x32_bf16 v[148:151], a[128:131], a[20:23], v[148:151]
v_fmac_f32 v182, s9, v246
v_fmac_f32 v183, s9, v247
v_mfma_f32_16x16x32_bf16 v[152:155], a[128:131], a[24:27], v[152:155]
v_fmac_f32 v184, s9, v248
v_fmac_f32 v185, s9, v249
v_mfma_f32_16x16x32_bf16 v[156:159], a[128:131], a[28:31], v[156:159]
s_waitcnt vmcnt(18) lgkmcnt(0)
buffer_load_dwordx4 a[224:227], v14, s[24:27], s40 offen offset:0
v_fmac_f32 v186, s9, v250
v_mfma_f32_16x16x32_bf16 v[96:99], a[136:139], a[32:35], v[96:99]
ds_read_b128 a[48:51], v4 offset:2272
ds_read_b128 a[52:55], v4 offset:6880
v_mfma_f32_16x16x32_bf16 v[100:103], a[136:139], a[36:39], v[100:103]
ds_read_b128 a[56:59], v4 offset:11488
ds_read_b128 a[60:63], v4 offset:16096
v_mfma_f32_16x16x32_bf16 v[104:107], a[136:139], a[40:43], v[104:107]
ds_read_b128 a[0:3], v4 offset:2336
ds_read_b128 a[4:7], v4 offset:6944
v_mfma_f32_16x16x32_bf16 v[108:111], a[136:139], a[44:47], v[108:111]
buffer_load_dwordx4 a[228:231], v14, s[24:27], s40 offen offset:1024
ds_read_b128 a[8:11], v4 offset:11552
v_mfma_f32_16x16x32_bf16 v[140:143], a[140:143], a[44:47], v[140:143]
ds_read_b128 a[12:15], v4 offset:16160
v_fmac_f32_e64 v187, s9, v251
v_mfma_f32_16x16x32_bf16 v[136:139], a[140:143], a[40:43], v[136:139]
v_fmac_f32 v188, s9, v252
v_fmac_f32 v189, s9, v253
v_mfma_f32_16x16x32_bf16 v[132:135], a[140:143], a[36:39], v[132:135]
v_fmac_f32 v190, s9, v254
v_fmac_f32 v191, s9, v255
v_mfma_f32_16x16x32_bf16 v[128:131], a[140:143], a[32:35], v[128:131]
v_mfma_f32_16x16x32_bf16 v[144:147], a[144:147], a[32:35], v[144:147]
buffer_load_dwordx4 a[232:235], v14, s[24:27], s40 offen offset:2048
v_mfma_f32_16x16x32_bf16 v[148:151], a[144:147], a[36:39], v[148:151]
v_mfma_f32_16x16x32_bf16 v[152:155], a[144:147], a[40:43], v[152:155]
v_mfma_f32_16x16x32_bf16 v[156:159], a[144:147], a[44:47], v[156:159]
s_waitcnt vmcnt(19) lgkmcnt(4)
v_mfma_f32_16x16x32_bf16 v[192:195], a[148:151], a[48:51], v[192:195]
buffer_load_dwordx4 a[236:239], v14, s[24:27], s40 offen offset:3072
ds_read_b128 a[16:19], v4 offset:2400
v_mfma_f32_16x16x32_bf16 v[196:199], a[148:151], a[52:55], v[196:199]
ds_read_b128 a[20:23], v4 offset:7008
ds_read_b128 a[24:27], v4 offset:11616
v_mfma_f32_16x16x32_bf16 v[200:203], a[148:151], a[56:59], v[200:203]
ds_read_b128 a[28:31], v4 offset:16224
v_fmac_f32 v208, s10, v144
v_mfma_f32_16x16x32_bf16 v[204:207], a[148:151], a[60:63], v[204:207]
ds_write_b128 v76, v[96:99] offset:0
v_mfma_f32_16x16x32_bf16 v[220:223], a[156:159], a[60:63], v[220:223]
ds_write_b128 v76, v[100:103] offset:1024
v_mfma_f32_16x16x32_bf16 v[216:219], a[156:159], a[56:59], v[216:219]
buffer_load_dwordx4 a[240:243], v15, s[24:27], s40 offen offset:0
v_fmac_f32_e64 v192, s10, v128
v_mfma_f32_16x16x32_bf16 v[212:215], a[156:159], a[52:55], v[212:215]
ds_write_b128 v76, v[104:107] offset:2048
v_mfma_f32_16x16x32_bf16 v[208:211], a[156:159], a[48:51], v[208:211]
s_waitcnt vmcnt(19) lgkmcnt(7)
ds_write_b128 v76, v[108:111] offset:3072
v_mfma_f32_16x16x32_bf16 v[192:195], a[160:163], a[0:3], v[192:195]
ds_read_b128 a[32:35], v4 offset:2464
ds_read_b128 a[36:39], v4 offset:7072
v_mfma_f32_16x16x32_bf16 v[196:199], a[160:163], a[4:7], v[196:199]
buffer_load_dwordx4 a[244:247], v15, s[24:27], s40 offen offset:1024
ds_read_b128 a[40:43], v4 offset:11680
v_mfma_f32_16x16x32_bf16 v[200:203], a[160:163], a[8:11], v[200:203]
ds_read_b128 a[44:47], v4 offset:16288
v_fmac_f32 v209, s10, v145
v_mfma_f32_16x16x32_bf16 v[204:207], a[160:163], a[12:15], v[204:207]
v_fmac_f32 v193, s10, v129
v_fmac_f32 v194, s10, v130
v_mfma_f32_16x16x32_bf16 v[220:223], a[164:167], a[12:15], v[220:223]
v_fmac_f32 v195, s10, v131
v_fmac_f32 v196, s10, v132
v_mfma_f32_16x16x32_bf16 v[216:219], a[164:167], a[8:11], v[216:219]
buffer_load_dwordx4 a[248:251], v15, s[24:27], s40 offen offset:2048
v_fmac_f32_e64 v197, s10, v133
v_mfma_f32_16x16x32_bf16 v[212:215], a[164:167], a[4:7], v[212:215]
v_fmac_f32 v198, s10, v134
v_fmac_f32 v199, s10, v135
v_mfma_f32_16x16x32_bf16 v[208:211], a[164:167], a[0:3], v[208:211]
s_waitcnt vmcnt(19) lgkmcnt(8)
v_fmac_f32 v200, s10, v136
v_fmac_f32_e64 v201, s10, v137
v_mfma_f32_16x16x32_bf16 v[192:195], a[168:171], a[16:19], v[192:195]
ds_read_b128 a[48:51], v5 offset:0
ds_read_b128 a[52:55], v5 offset:4608
v_mfma_f32_16x16x32_bf16 v[196:199], a[168:171], a[20:23], v[196:199]
s_waitcnt lgkmcnt(6)
s_barrier
v_mfma_f32_16x16x32_bf16 v[200:203], a[168:171], a[24:27], v[200:203]
ds_read_b128 a[56:59], v5 offset:9216
ds_read_b128 a[60:63], v5 offset:13824
v_mfma_f32_16x16x32_bf16 v[204:207], a[168:171], a[28:31], v[204:207]
buffer_load_dwordx4 a[252:255], v15, s[24:27], s40 offen offset:3072
ds_read_b128 v[24:27], v77 offset:0
v_mfma_f32_16x16x32_bf16 v[220:223], a[172:175], a[28:31], v[220:223]
ds_read_b128 v[28:31], v77 offset:1024
ds_read_b128 v[32:35], v77 offset:2048
v_mfma_f32_16x16x32_bf16 v[216:219], a[172:175], a[24:27], v[216:219]
ds_read_b128 v[36:39], v77 offset:3072
v_fmac_f32_e64 v202, s10, v138
v_mfma_f32_16x16x32_bf16 v[212:215], a[172:175], a[20:23], v[212:215]
v_fmac_f32 v203, s10, v139
v_fmac_f32 v204, s10, v140
v_mfma_f32_16x16x32_bf16 v[208:211], a[172:175], a[16:19], v[208:211]
s_waitcnt vmcnt(18) lgkmcnt(8)
s_add_u32 s40, s40, 16384
buffer_load_dwordx4 a[72:75], v12, s[24:27], s40 offen offset:0
v_fmac_f32 v205, s10, v141
v_mfma_f32_16x16x32_bf16 v[192:195], a[176:179], a[32:35], v[192:195]
ds_read_b128 a[0:3], v4 offset:0
ds_read_b128 a[4:7], v4 offset:4608
v_mfma_f32_16x16x32_bf16 v[196:199], a[176:179], a[36:39], v[196:199]
ds_read_b128 a[8:11], v4 offset:9216
ds_read_b128 a[12:15], v4 offset:13824
s_waitcnt lgkmcnt(4)
v_mfma_f32_16x16x32_bf16 v[200:203], a[176:179], a[40:43], v[200:203]
v_fmac_f32 v210, s10, v146
v_fmac_f32_e64 v211, s10, v147
v_mfma_f32_16x16x32_bf16 v[204:207], a[176:179], a[44:47], v[204:207]
v_fmac_f32 v212, s10, v148
v_fmac_f32 v213, s10, v149
v_mfma_f32_16x16x32_bf16 v[220:223], a[180:183], a[44:47], v[220:223]
buffer_load_dwordx4 a[64:67], v12, s[24:27], s40 offen offset:1024
v_fmac_f32_e64 v112, s82, v96
v_mfma_f32_16x16x32_bf16 v[216:219], a[180:183], a[40:43], v[216:219]
v_fmac_f32 v113, s82, v97
v_fmac_f32 v114, s82, v98
v_mfma_f32_16x16x32_bf16 v[212:215], a[180:183], a[36:39], v[212:215]
v_fmac_f32 v206, s10, v142
v_fmac_f32 v207, s10, v143
v_mfma_f32_16x16x32_bf16 v[208:211], a[180:183], a[32:35], v[208:211]
s_waitcnt vmcnt(18)
v_fmac_f32 v220, s10, v156
v_fmac_f32_e64 v221, s10, v157
v_mfma_f32_16x16x32_bf16 v[192:195], a[184:187], a[48:51], v[192:195]
buffer_load_dwordx4 a[68:71], v12, s[24:27], s40 offen offset:2048
ds_read_b128 a[16:19], v4 offset:64
v_mfma_f32_16x16x32_bf16 v[196:199], a[184:187], a[52:55], v[196:199]
ds_read_b128 a[20:23], v4 offset:4672
ds_read_b128 a[24:27], v4 offset:9280
v_mfma_f32_16x16x32_bf16 v[200:203], a[184:187], a[56:59], v[200:203]
ds_read_b128 a[28:31], v4 offset:13888
v_fmac_f32_e64 v214, s10, v150
v_mfma_f32_16x16x32_bf16 v[204:207], a[184:187], a[60:63], v[204:207]
v_fmac_f32 v215, s10, v151
v_fmac_f32 v115, s82, v99
v_mfma_f32_16x16x32_bf16 v[220:223], a[188:191], a[60:63], v[220:223]
buffer_load_dwordx4 a[76:79], v12, s[24:27], s40 offen offset:3072
v_fmac_f32_e64 v116, s82, v100
v_mfma_f32_16x16x32_bf16 v[216:219], a[188:191], a[56:59], v[216:219]
v_fmac_f32 v117, s82, v101
v_fmac_f32 v118, s82, v102
v_mfma_f32_16x16x32_bf16 v[212:215], a[188:191], a[52:55], v[212:215]
v_fmac_f32 v119, s82, v103
v_fmac_f32 v120, s82, v104
v_mfma_f32_16x16x32_bf16 v[208:211], a[188:191], a[48:51], v[208:211]
s_waitcnt vmcnt(18) lgkmcnt(4)
v_fmac_f32 v222, s10, v158
v_fmac_f32_e64 v223, s10, v159
v_mfma_f32_16x16x32_bf16 v[192:195], a[192:195], a[0:3], v[192:195]
ds_read_b128 a[32:35], v4 offset:128
ds_read_b128 a[36:39], v4 offset:4736
v_mfma_f32_16x16x32_bf16 v[196:199], a[192:195], a[4:7], v[196:199]
buffer_load_dwordx4 a[80:83], v13, s[24:27], s40 offen offset:0
ds_read_b128 a[40:43], v4 offset:9344
v_mfma_f32_16x16x32_bf16 v[200:203], a[192:195], a[8:11], v[200:203]
ds_read_b128 a[44:47], v4 offset:13952
v_fmac_f32_e64 v216, s10, v152
v_mfma_f32_16x16x32_bf16 v[204:207], a[192:195], a[12:15], v[204:207]
v_fmac_f32 v121, s82, v105
v_fmac_f32 v122, s82, v106
v_mfma_f32_16x16x32_bf16 v[220:223], a[196:199], a[12:15], v[220:223]
v_fmac_f32 v123, s82, v107
v_fmac_f32 v124, s82, v108
v_mfma_f32_16x16x32_bf16 v[216:219], a[196:199], a[8:11], v[216:219]
buffer_load_dwordx4 a[92:95], v13, s[24:27], s40 offen offset:1024
v_fmac_f32_e64 v125, s82, v109
v_mfma_f32_16x16x32_bf16 v[212:215], a[196:199], a[4:7], v[212:215]
v_fmac_f32 v126, s82, v110
v_fmac_f32 v127, s82, v111
v_mfma_f32_16x16x32_bf16 v[208:211], a[196:199], a[0:3], v[208:211]
s_waitcnt vmcnt(18) lgkmcnt(4)
v_fmac_f32 v112, s83, v24
v_fmac_f32_e64 v113, s83, v25
v_mfma_f32_16x16x32_bf16 v[192:195], a[200:203], a[16:19], v[192:195]
ds_read_b128 a[48:51], v4 offset:192
ds_read_b128 a[52:55], v4 offset:4800
v_mfma_f32_16x16x32_bf16 v[196:199], a[200:203], a[20:23], v[196:199]
ds_read_b128 a[56:59], v4 offset:9408
ds_read_b128 a[60:63], v4 offset:14016
v_mfma_f32_16x16x32_bf16 v[200:203], a[200:203], a[24:27], v[200:203]
buffer_load_dwordx4 a[84:87], v13, s[24:27], s40 offen offset:2048
v_fmac_f32_e64 v217, s10, v153
v_mfma_f32_16x16x32_bf16 v[204:207], a[200:203], a[28:31], v[204:207]
v_fmac_f32 v114, s83, v26
v_fmac_f32 v115, s83, v27
v_mfma_f32_16x16x32_bf16 v[220:223], a[204:207], a[28:31], v[220:223]
v_fmac_f32 v116, s83, v28
v_fmac_f32 v117, s83, v29
v_mfma_f32_16x16x32_bf16 v[216:219], a[204:207], a[24:27], v[216:219]
v_fmac_f32 v118, s83, v30
v_fmac_f32 v119, s83, v31
v_mfma_f32_16x16x32_bf16 v[212:215], a[204:207], a[20:23], v[212:215]
buffer_load_dwordx4 a[88:91], v13, s[24:27], s40 offen offset:3072
v_fmac_f32_e64 v120, s83, v32
v_mfma_f32_16x16x32_bf16 v[208:211], a[204:207], a[16:19], v[208:211]
s_waitcnt vmcnt(18) lgkmcnt(4)
v_fmac_f32 v121, s83, v33
v_fmac_f32_e64 v122, s83, v34
v_mfma_f32_16x16x32_bf16 v[192:195], a[208:211], a[32:35], v[192:195]
ds_read_b128 a[0:3], v2 offset:47872
ds_read_b128 a[4:7], v2 offset:52480
v_mfma_f32_16x16x32_bf16 v[196:199], a[208:211], a[36:39], v[196:199]
ds_read_b128 a[8:11], v2 offset:57088
ds_read_b128 a[12:15], v2 offset:61696
v_mfma_f32_16x16x32_bf16 v[200:203], a[208:211], a[40:43], v[200:203]
buffer_load_dwordx4 a[96:99], v14, s[24:27], s40 offen offset:0
v_fmac_f32_e64 v218, s10, v154
v_mfma_f32_16x16x32_bf16 v[204:207], a[208:211], a[44:47], v[204:207]
v_fmac_f32 v123, s83, v35
v_fmac_f32 v124, s83, v36
v_mfma_f32_16x16x32_bf16 v[220:223], a[212:215], a[44:47], v[220:223]
v_fmac_f32 v125, s83, v37
v_fmac_f32 v126, s83, v38
v_mfma_f32_16x16x32_bf16 v[216:219], a[212:215], a[40:43], v[216:219]
v_fmac_f32_e64 v127, s83, v39
v_mfma_f32_16x16x32_bf16 v[212:215], a[212:215], a[36:39], v[212:215]
v_mfma_f32_16x16x32_bf16 v[208:211], a[212:215], a[32:35], v[208:211]
s_waitcnt vmcnt(17) lgkmcnt(4)
buffer_load_dwordx4 a[100:103], v14, s[24:27], s40 offen offset:1024
v_mfma_f32_16x16x32_bf16 v[192:195], a[216:219], a[48:51], v[192:195]
ds_read_b128 a[16:19], v2 offset:47936
ds_read_b128 a[20:23], v2 offset:52544
v_mfma_f32_16x16x32_bf16 v[196:199], a[216:219], a[52:55], v[196:199]
ds_read_b128 a[24:27], v2 offset:57152
ds_read_b128 a[28:31], v2 offset:61760
v_mfma_f32_16x16x32_bf16 v[200:203], a[216:219], a[56:59], v[200:203]
v_fmac_f32 v219, s10, v155
v_mfma_f32_16x16x32_bf16 v[204:207], a[216:219], a[60:63], v[204:207]
buffer_load_dwordx4 a[112:115], v14, s[24:27], s40 offen offset:2048
v_mfma_f32_16x16x32_bf16 v[220:223], a[220:223], a[60:63], v[220:223]
v_mfma_f32_16x16x32_bf16 v[216:219], a[220:223], a[56:59], v[216:219]
v_mfma_f32_16x16x32_bf16 v[212:215], a[220:223], a[52:55], v[212:215]
v_mfma_f32_16x16x32_bf16 v[208:211], a[220:223], a[48:51], v[208:211]
s_waitcnt vmcnt(16) lgkmcnt(4)
v_mfma_f32_16x16x32_bf16 v[112:115], a[224:227], a[0:3], v[112:115]
buffer_load_dwordx4 a[132:135], v14, s[24:27], s40 offen offset:3072
v_fmac_f32 v128, s11, v192
v_mfma_f32_16x16x32_bf16 v[116:119], a[224:227], a[4:7], v[116:119]
v_fmac_f32 v129, s11, v193
v_fmac_f32 v130, s11, v194
v_mfma_f32_16x16x32_bf16 v[120:123], a[224:227], a[8:11], v[120:123]
v_fmac_f32 v131, s11, v195
v_fmac_f32 v132, s11, v196
v_mfma_f32_16x16x32_bf16 v[124:127], a[224:227], a[12:15], v[124:127]
v_fmac_f32 v133, s11, v197
v_fmac_f32 v134, s11, v198
v_mfma_f32_16x16x32_bf16 v[140:143], a[228:231], a[12:15], v[140:143]
buffer_load_dwordx4 a[152:155], v15, s[24:27], s40 offen offset:0
v_fmac_f32_e64 v144, s11, v208
v_mfma_f32_16x16x32_bf16 v[136:139], a[228:231], a[8:11], v[136:139]
v_fmac_f32 v145, s11, v209
v_fmac_f32 v146, s11, v210
v_mfma_f32_16x16x32_bf16 v[132:135], a[228:231], a[4:7], v[132:135]
v_fmac_f32 v148, s11, v212
v_fmac_f32 v149, s11, v213
v_mfma_f32_16x16x32_bf16 v[128:131], a[228:231], a[0:3], v[128:131]
v_fmac_f32 v140, s11, v204
v_fmac_f32 v141, s11, v205
v_mfma_f32_16x16x32_bf16 v[144:147], a[232:235], a[0:3], v[144:147]
v_fmac_f32 v136, s11, v200
v_fmac_f32 v137, s11, v201
v_mfma_f32_16x16x32_bf16 v[148:151], a[232:235], a[4:7], v[148:151]
buffer_load_dwordx4 a[104:107], v15, s[24:27], s40 offen offset:1024
v_fmac_f32_e64 v135, s11, v199
v_mfma_f32_16x16x32_bf16 v[152:155], a[232:235], a[8:11], v[152:155]
v_fmac_f32 v138, s11, v202
v_fmac_f32 v139, s11, v203
v_mfma_f32_16x16x32_bf16 v[156:159], a[232:235], a[12:15], v[156:159]
s_waitcnt vmcnt(16) lgkmcnt(0)
v_fmac_f32 v142, s11, v206
v_fmac_f32_e64 v143, s11, v207
v_mfma_f32_16x16x32_bf16 v[112:115], a[236:239], a[16:19], v[112:115]
ds_read_b128 a[32:35], v2 offset:48000
ds_read_b128 a[36:39], v2 offset:52608
v_mfma_f32_16x16x32_bf16 v[116:119], a[236:239], a[20:23], v[116:119]
buffer_load_dwordx4 a[108:111], v15, s[24:27], s40 offen offset:2048
ds_read_b128 a[40:43], v2 offset:57216
v_mfma_f32_16x16x32_bf16 v[120:123], a[236:239], a[24:27], v[120:123]
ds_read_b128 a[44:47], v2 offset:61824
v_fmac_f32_e64 v147, s11, v211
v_mfma_f32_16x16x32_bf16 v[124:127], a[236:239], a[28:31], v[124:127]
v_fmac_f32 v150, s11, v214
v_fmac_f32 v151, s11, v215
v_mfma_f32_16x16x32_bf16 v[140:143], a[240:243], a[28:31], v[140:143]
v_fmac_f32 v152, s11, v216
v_fmac_f32 v153, s11, v217
v_mfma_f32_16x16x32_bf16 v[136:139], a[240:243], a[24:27], v[136:139]
buffer_load_dwordx4 a[116:119], v15, s[24:27], s40 offen offset:3072
v_fmac_f32_e64 v154, s11, v218
v_mfma_f32_16x16x32_bf16 v[132:135], a[240:243], a[20:23], v[132:135]
v_fmac_f32 v155, s11, v219
v_fmac_f32 v156, s11, v220
v_mfma_f32_16x16x32_bf16 v[128:131], a[240:243], a[16:19], v[128:131]
v_fmac_f32 v157, s11, v221
v_fmac_f32 v158, s11, v222
v_mfma_f32_16x16x32_bf16 v[144:147], a[244:247], a[16:19], v[144:147]
v_fmac_f32_e64 v159, s11, v223
v_mfma_f32_16x16x32_bf16 v[148:151], a[244:247], a[20:23], v[148:151]
v_mfma_f32_16x16x32_bf16 v[152:155], a[244:247], a[24:27], v[152:155]
s_add_u32 s40, s40, 16384
buffer_load_dwordx4 a[120:123], v12, s[24:27], s40 offen offset:0
v_mfma_f32_16x16x32_bf16 v[156:159], a[244:247], a[28:31], v[156:159]
s_waitcnt vmcnt(16) lgkmcnt(0)
v_mfma_f32_16x16x32_bf16 v[112:115], a[248:251], a[32:35], v[112:115]
ds_read_b128 a[48:51], v2 offset:48064
ds_read_b128 a[52:55], v2 offset:52672
v_mfma_f32_16x16x32_bf16 v[116:119], a[248:251], a[36:39], v[116:119]
ds_read_b128 a[56:59], v2 offset:57280
ds_read_b128 a[60:63], v2 offset:61888
v_mfma_f32_16x16x32_bf16 v[120:123], a[248:251], a[40:43], v[120:123]
buffer_load_dwordx4 a[124:127], v12, s[24:27], s40 offen offset:1024
v_mfma_f32_16x16x32_bf16 v[124:127], a[248:251], a[44:47], v[124:127]
v_mfma_f32_16x16x32_bf16 v[140:143], a[252:255], a[44:47], v[140:143]
v_mfma_f32_16x16x32_bf16 v[136:139], a[252:255], a[40:43], v[136:139]
v_mfma_f32_16x16x32_bf16 v[132:135], a[252:255], a[36:39], v[132:135]
v_mfma_f32_16x16x32_bf16 v[128:131], a[252:255], a[32:35], v[128:131]
buffer_load_dwordx4 a[128:131], v12, s[24:27], s40 offen offset:2048
v_mfma_f32_16x16x32_bf16 v[144:147], a[72:75], a[32:35], v[144:147]
v_mfma_f32_16x16x32_bf16 v[148:151], a[72:75], a[36:39], v[148:151]
v_mfma_f32_16x16x32_bf16 v[152:155], a[72:75], a[40:43], v[152:155]
v_mfma_f32_16x16x32_bf16 v[156:159], a[72:75], a[44:47], v[156:159]
s_waitcnt vmcnt(15) lgkmcnt(0)
buffer_load_dwordx4 a[136:139], v12, s[24:27], s40 offen offset:3072
v_mfma_f32_16x16x32_bf16 v[112:115], a[64:67], a[48:51], v[112:115]
ds_read_b128 a[0:3], v3 offset:45600
ds_read_b128 a[4:7], v3 offset:50208
v_mfma_f32_16x16x32_bf16 v[116:119], a[64:67], a[52:55], v[116:119]
ds_read_b128 a[8:11], v3 offset:54816
ds_read_b128 a[12:15], v3 offset:59424
v_mfma_f32_16x16x32_bf16 v[120:123], a[64:67], a[56:59], v[120:123]
v_mfma_f32_16x16x32_bf16 v[124:127], a[64:67], a[60:63], v[124:127]
buffer_load_dwordx4 a[140:143], v13, s[24:27], s40 offen offset:0
v_mfma_f32_16x16x32_bf16 v[140:143], a[68:71], a[60:63], v[140:143]
v_mfma_f32_16x16x32_bf16 v[136:139], a[68:71], a[56:59], v[136:139]
v_mfma_f32_16x16x32_bf16 v[132:135], a[68:71], a[52:55], v[132:135]
v_mfma_f32_16x16x32_bf16 v[128:131], a[68:71], a[48:51], v[128:131]
v_mfma_f32_16x16x32_bf16 v[144:147], a[76:79], a[48:51], v[144:147]
buffer_load_dwordx4 a[144:147], v13, s[24:27], s40 offen offset:1024
v_mfma_f32_16x16x32_bf16 v[148:151], a[76:79], a[52:55], v[148:151]
v_mfma_f32_16x16x32_bf16 v[152:155], a[76:79], a[56:59], v[152:155]
v_mfma_f32_16x16x32_bf16 v[156:159], a[76:79], a[60:63], v[156:159]
s_waitcnt vmcnt(15) lgkmcnt(0)
v_mfma_f32_16x16x32_bf16 v[112:115], a[80:83], a[0:3], v[112:115]
buffer_load_dwordx4 a[148:151], v13, s[24:27], s40 offen offset:2048
ds_read_b128 a[16:19], v2 offset:45600
v_mfma_f32_16x16x32_bf16 v[116:119], a[80:83], a[4:7], v[116:119]
ds_read_b128 a[20:23], v2 offset:50208
ds_read_b128 a[24:27], v2 offset:54816
v_mfma_f32_16x16x32_bf16 v[120:123], a[80:83], a[8:11], v[120:123]
ds_read_b128 a[28:31], v2 offset:59424
v_mfma_f32_16x16x32_bf16 v[124:127], a[80:83], a[12:15], v[124:127]
v_mfma_f32_16x16x32_bf16 v[140:143], a[92:95], a[12:15], v[140:143]
v_mfma_f32_16x16x32_bf16 v[136:139], a[92:95], a[8:11], v[136:139]
buffer_load_dwordx4 a[156:159], v13, s[24:27], s40 offen offset:3072
v_mfma_f32_16x16x32_bf16 v[132:135], a[92:95], a[4:7], v[132:135]
v_mfma_f32_16x16x32_bf16 v[128:131], a[92:95], a[0:3], v[128:131]
v_mfma_f32_16x16x32_bf16 v[144:147], a[84:87], a[0:3], v[144:147]
v_mfma_f32_16x16x32_bf16 v[148:151], a[84:87], a[4:7], v[148:151]
buffer_load_dwordx4 a[160:163], v14, s[24:27], s40 offen offset:0
v_mfma_f32_16x16x32_bf16 v[152:155], a[84:87], a[8:11], v[152:155]
v_mfma_f32_16x16x32_bf16 v[156:159], a[84:87], a[12:15], v[156:159]
s_waitcnt vmcnt(15) lgkmcnt(0)
v_mfma_f32_16x16x32_bf16 v[112:115], a[88:91], a[16:19], v[112:115]
ds_read_b128 a[32:35], v2 offset:45664
ds_read_b128 a[36:39], v2 offset:50272
v_mfma_f32_16x16x32_bf16 v[116:119], a[88:91], a[20:23], v[116:119]
buffer_load_dwordx4 a[164:167], v14, s[24:27], s40 offen offset:1024
ds_read_b128 a[40:43], v2 offset:54880
v_mfma_f32_16x16x32_bf16 v[120:123], a[88:91], a[24:27], v[120:123]
ds_read_b128 a[44:47], v2 offset:59488
v_mfma_f32_16x16x32_bf16 v[124:127], a[88:91], a[28:31], v[124:127]
v_mfma_f32_16x16x32_bf16 v[140:143], a[96:99], a[28:31], v[140:143]
v_mfma_f32_16x16x32_bf16 v[136:139], a[96:99], a[24:27], v[136:139]
v_mfma_f32_16x16x32_bf16 v[132:135], a[96:99], a[20:23], v[132:135]
buffer_load_dwordx4 a[168:171], v14, s[24:27], s40 offen offset:2048
v_mfma_f32_16x16x32_bf16 v[128:131], a[96:99], a[16:19], v[128:131]
v_mfma_f32_16x16x32_bf16 v[144:147], a[100:103], a[16:19], v[144:147]
v_mfma_f32_16x16x32_bf16 v[148:151], a[100:103], a[20:23], v[148:151]
v_mfma_f32_16x16x32_bf16 v[152:155], a[100:103], a[24:27], v[152:155]
buffer_load_dwordx4 a[172:175], v14, s[24:27], s40 offen offset:3072
v_mfma_f32_16x16x32_bf16 v[156:159], a[100:103], a[28:31], v[156:159]
s_waitcnt vmcnt(15) lgkmcnt(0)
v_mfma_f32_16x16x32_bf16 v[112:115], a[112:115], a[32:35], v[112:115]
ds_read_b128 a[48:51], v2 offset:45728
ds_read_b128 a[52:55], v2 offset:50336
v_mfma_f32_16x16x32_bf16 v[116:119], a[112:115], a[36:39], v[116:119]
ds_read_b128 a[56:59], v2 offset:54944
ds_read_b128 a[60:63], v2 offset:59552
v_mfma_f32_16x16x32_bf16 v[120:123], a[112:115], a[40:43], v[120:123]
v_mfma_f32_16x16x32_bf16 v[124:127], a[112:115], a[44:47], v[124:127]
buffer_load_dwordx4 a[176:179], v15, s[24:27], s40 offen offset:0
v_mfma_f32_16x16x32_bf16 v[140:143], a[132:135], a[44:47], v[140:143]
v_mfma_f32_16x16x32_bf16 v[136:139], a[132:135], a[40:43], v[136:139]
v_mfma_f32_16x16x32_bf16 v[132:135], a[132:135], a[36:39], v[132:135]
v_mfma_f32_16x16x32_bf16 v[128:131], a[132:135], a[32:35], v[128:131]
buffer_load_dwordx4 a[180:183], v15, s[24:27], s40 offen offset:1024
v_mfma_f32_16x16x32_bf16 v[144:147], a[152:155], a[32:35], v[144:147]
v_mfma_f32_16x16x32_bf16 v[148:151], a[152:155], a[36:39], v[148:151]
v_mfma_f32_16x16x32_bf16 v[152:155], a[152:155], a[40:43], v[152:155]
v_mfma_f32_16x16x32_bf16 v[156:159], a[152:155], a[44:47], v[156:159]
s_waitcnt vmcnt(14) lgkmcnt(0)
v_mfma_f32_16x16x32_bf16 v[112:115], a[104:107], a[48:51], v[112:115]
buffer_load_dwordx4 a[184:187], v15, s[24:27], s40 offen offset:2048
ds_read_b128 a[0:3], v2 offset:45792
v_mfma_f32_16x16x32_bf16 v[116:119], a[104:107], a[52:55], v[116:119]
ds_read_b128 a[4:7], v2 offset:50400
ds_read_b128 a[8:11], v2 offset:55008
v_mfma_f32_16x16x32_bf16 v[120:123], a[104:107], a[56:59], v[120:123]
ds_read_b128 a[12:15], v2 offset:59616
v_mfma_f32_16x16x32_bf16 v[124:127], a[104:107], a[60:63], v[124:127]
v_mfma_f32_16x16x32_bf16 v[140:143], a[108:111], a[60:63], v[140:143]
buffer_load_dwordx4 a[188:191], v15, s[24:27], s40 offen offset:3072
v_mfma_f32_16x16x32_bf16 v[136:139], a[108:111], a[56:59], v[136:139]
v_mfma_f32_16x16x32_bf16 v[132:135], a[108:111], a[52:55], v[132:135]
v_mfma_f32_16x16x32_bf16 v[128:131], a[108:111], a[48:51], v[128:131]
v_mfma_f32_16x16x32_bf16 v[144:147], a[116:119], a[48:51], v[144:147]
s_add_u32 s40, s40, 16384
buffer_load_dwordx4 a[192:195], v12, s[24:27], s40 offen offset:0
v_mfma_f32_16x16x32_bf16 v[148:151], a[116:119], a[52:55], v[148:151]
v_mfma_f32_16x16x32_bf16 v[152:155], a[116:119], a[56:59], v[152:155]
v_mfma_f32_16x16x32_bf16 v[156:159], a[116:119], a[60:63], v[156:159]
s_waitcnt vmcnt(14) lgkmcnt(0)
v_mfma_f32_16x16x32_bf16 v[112:115], a[120:123], a[0:3], v[112:115]
ds_read_b128 a[16:19], v4 offset:47872
ds_read_b128 a[20:23], v4 offset:52480
v_mfma_f32_16x16x32_bf16 v[116:119], a[120:123], a[4:7], v[116:119]
buffer_load_dwordx4 a[196:199], v12, s[24:27], s40 offen offset:1024
ds_read_b128 a[24:27], v4 offset:57088
v_mfma_f32_16x16x32_bf16 v[120:123], a[120:123], a[8:11], v[120:123]
ds_read_b128 a[28:31], v4 offset:61696
ds_read_b128 a[32:35], v4 offset:47936
v_mfma_f32_16x16x32_bf16 v[124:127], a[120:123], a[12:15], v[124:127]
ds_read_b128 a[36:39], v4 offset:52544
ds_read_b128 a[40:43], v4 offset:57152
v_mfma_f32_16x16x32_bf16 v[140:143], a[124:127], a[12:15], v[140:143]
ds_read_b128 a[44:47], v4 offset:61760
v_mfma_f32_16x16x32_bf16 v[136:139], a[124:127], a[8:11], v[136:139]
buffer_load_dwordx4 a[200:203], v12, s[24:27], s40 offen offset:2048
v_mfma_f32_16x16x32_bf16 v[132:135], a[124:127], a[4:7], v[132:135]
v_mfma_f32_16x16x32_bf16 v[128:131], a[124:127], a[0:3], v[128:131]
v_mfma_f32_16x16x32_bf16 v[144:147], a[128:131], a[0:3], v[144:147]
v_mfma_f32_16x16x32_bf16 v[148:151], a[128:131], a[4:7], v[148:151]
v_mfma_f32_16x16x32_bf16 v[152:155], a[128:131], a[8:11], v[152:155]
buffer_load_dwordx4 a[204:207], v12, s[24:27], s40 offen offset:3072
v_mfma_f32_16x16x32_bf16 v[156:159], a[128:131], a[12:15], v[156:159]
s_waitcnt vmcnt(15) lgkmcnt(4)
v_mfma_f32_16x16x32_bf16 v[192:195], a[136:139], a[16:19], v[192:195]
ds_read_b128 a[48:51], v4 offset:48000
ds_read_b128 a[52:55], v4 offset:52608
v_mfma_f32_16x16x32_bf16 v[196:199], a[136:139], a[20:23], v[196:199]
ds_read_b128 a[56:59], v4 offset:57216
ds_read_b128 a[60:63], v4 offset:61824
v_mfma_f32_16x16x32_bf16 v[200:203], a[136:139], a[24:27], v[200:203]
buffer_load_dwordx4 a[208:211], v13, s[24:27], s40 offen offset:0
v_min_f32 v128, s12, v128
v_min_f32 v129, s12, v129
v_mfma_f32_16x16x32_bf16 v[204:207], a[136:139], a[28:31], v[204:207]
v_min_f32 v130, s12, v130
v_min_f32 v131, s12, v131
v_min_f32_e64 v132, s12, v132
v_mfma_f32_16x16x32_bf16 v[220:223], a[140:143], a[28:31], v[220:223]
v_min_f32 v133, s12, v133
v_min_f32 v134, s12, v134
v_min_f32_e64 v135, s12, v135
v_mfma_f32_16x16x32_bf16 v[216:219], a[140:143], a[24:27], v[216:219]
v_exp_f32_e64 v144, v144
v_mfma_f32_16x16x32_bf16 v[212:215], a[140:143], a[20:23], v[212:215]
L_isl5:
s_cbranch_execz L_wret
buffer_load_dwordx4 a[212:215], v13, s[24:27], s40 offen offset:1024
v_exp_f32 v145, v145
v_mfma_f32_16x16x32_bf16 v[208:211], a[140:143], a[16:19], v[208:211]
s_waitcnt vmcnt(15) lgkmcnt(4)
v_exp_f32 v146, v146
v_mfma_f32_16x16x32_bf16 v[192:195], a[144:147], a[32:35], v[192:195]
ds_read_b128 a[0:3], v4 offset:48064
ds_read_b128 a[4:7], v4 offset:52672
v_mfma_f32_16x16x32_bf16 v[196:199], a[144:147], a[36:39], v[196:199]
buffer_load_dwordx4 a[216:219], v13, s[24:27], s40 offen offset:2048
ds_read_b128 a[8:11], v4 offset:57280
v_mfma_f32_16x16x32_bf16 v[200:203], a[144:147], a[40:43], v[200:203]
ds_read_b128 a[12:15], v4 offset:61888
v_exp_f32_e64 v147, v147
v_mfma_f32_16x16x32_bf16 v[204:207], a[144:147], a[44:47], v[204:207]
v_exp_f32_e64 v148, v148
v_mfma_f32_16x16x32_bf16 v[220:223], a[148:151], a[44:47], v[220:223]
v_exp_f32_e64 v149, v149
v_mfma_f32_16x16x32_bf16 v[216:219], a[148:151], a[40:43], v[216:219]
buffer_load_dwordx4 a[220:223], v13, s[24:27], s40 offen offset:3072
v_exp_f32_e64 v150, v150
v_mfma_f32_16x16x32_bf16 v[212:215], a[148:151], a[36:39], v[212:215]
v_exp_f32_e64 v151, v151
v_mfma_f32_16x16x32_bf16 v[208:211], a[148:151], a[32:35], v[208:211]
s_waitcnt vmcnt(15) lgkmcnt(4)
v_exp_f32 v128, v128
v_mfma_f32_16x16x32_bf16 v[192:195], a[156:159], a[48:51], v[192:195]
ds_read_b128 a[16:19], v5 offset:45600
ds_read_b128 a[20:23], v5 offset:50208
v_mfma_f32_16x16x32_bf16 v[196:199], a[156:159], a[52:55], v[196:199]
buffer_load_dwordx4 a[224:227], v14, s[24:27], s40 offen offset:0
ds_read_b128 a[24:27], v5 offset:54816
v_mfma_f32_16x16x32_bf16 v[200:203], a[156:159], a[56:59], v[200:203]
ds_read_b128 a[28:31], v5 offset:59424
v_exp_f32_e64 v129, v129
v_mfma_f32_16x16x32_bf16 v[204:207], a[156:159], a[60:63], v[204:207]
v_exp_f32_e64 v130, v130
v_mfma_f32_16x16x32_bf16 v[220:223], a[160:163], a[60:63], v[220:223]
v_exp_f32_e64 v131, v131
v_mfma_f32_16x16x32_bf16 v[216:219], a[160:163], a[56:59], v[216:219]
buffer_load_dwordx4 a[228:231], v14, s[24:27], s40 offen offset:1024
v_exp_f32_e64 v132, v132
v_mfma_f32_16x16x32_bf16 v[212:215], a[160:163], a[52:55], v[212:215]
v_exp_f32_e64 v133, v133
v_mfma_f32_16x16x32_bf16 v[208:211], a[160:163], a[48:51], v[208:211]
s_waitcnt vmcnt(15) lgkmcnt(4)
v_exp_f32 v134, v134
v_mfma_f32_16x16x32_bf16 v[192:195], a[164:167], a[0:3], v[192:195]
buffer_load_dwordx4 a[232:235], v14, s[24:27], s40 offen offset:2048
ds_read_b128 a[32:35], v4 offset:45600
v_mfma_f32_16x16x32_bf16 v[196:199], a[164:167], a[4:7], v[196:199]
ds_read_b128 a[36:39], v4 offset:50208
ds_read_b128 a[40:43], v4 offset:54816
v_mfma_f32_16x16x32_bf16 v[200:203], a[164:167], a[8:11], v[200:203]
ds_read_b128 a[44:47], v4 offset:59424
v_exp_f32_e64 v135, v135
v_mfma_f32_16x16x32_bf16 v[204:207], a[164:167], a[12:15], v[204:207]
v_add_f32 v40, 1.0, v128
v_add_f32 v41, 1.0, v129
v_add_f32_e64 v42, 1.0, v130
v_mfma_f32_16x16x32_bf16 v[220:223], a[168:171], a[12:15], v[220:223]
buffer_load_dwordx4 a[236:239], v14, s[24:27], s40 offen offset:3072
v_add_f32 v43, 1.0, v131
v_add_f32 v44, 1.0, v132
v_mfma_f32_16x16x32_bf16 v[216:219], a[168:171], a[8:11], v[216:219]
v_add_f32 v45, 1.0, v133
v_add_f32 v46, 1.0, v134
v_add_f32_e64 v47, 1.0, v135
v_mfma_f32_16x16x32_bf16 v[212:215], a[168:171], a[4:7], v[212:215]
v_fma_f32 v40, v40, v144, v40
v_fma_f32 v41, v41, v145, v41
v_fma_f32 v42, v42, v146, v42
v_mfma_f32_16x16x32_bf16 v[208:211], a[168:171], a[0:3], v[208:211]
s_waitcnt vmcnt(15) lgkmcnt(4)
v_fma_f32 v43, v43, v147, v43
v_fma_f32 v44, v44, v148, v44
v_fma_f32 v45, v45, v149, v45
v_mfma_f32_16x16x32_bf16 v[192:195], a[172:175], a[16:19], v[192:195]
buffer_load_dwordx4 a[240:243], v15, s[24:27], s40 offen offset:0
ds_read_b128 a[48:51], v4 offset:45664
v_fma_f32 v46, v46, v150, v46
v_mfma_f32_16x16x32_bf16 v[196:199], a[172:175], a[20:23], v[196:199]
ds_read_b128 a[52:55], v4 offset:50272
ds_read_b128 a[56:59], v4 offset:54880
v_fma_f32 v47, v47, v151, v47
v_mfma_f32_16x16x32_bf16 v[200:203], a[172:175], a[24:27], v[200:203]
ds_read_b128 a[60:63], v4 offset:59488
v_rcp_f32 v40, v40
v_mfma_f32_16x16x32_bf16 v[204:207], a[172:175], a[28:31], v[204:207]
v_rcp_f32_e64 v41, v41
v_mfma_f32_16x16x32_bf16 v[220:223], a[176:179], a[28:31], v[220:223]
buffer_load_dwordx4 a[244:247], v15, s[24:27], s40 offen offset:1024
v_rcp_f32_e64 v42, v42
v_mfma_f32_16x16x32_bf16 v[216:219], a[176:179], a[24:27], v[216:219]
v_rcp_f32_e64 v43, v43
v_mfma_f32_16x16x32_bf16 v[212:215], a[176:179], a[20:23], v[212:215]
v_rcp_f32_e64 v44, v44
v_mfma_f32_16x16x32_bf16 v[208:211], a[176:179], a[16:19], v[208:211]
s_waitcnt vmcnt(15) lgkmcnt(4)
buffer_load_dwordx4 a[248:251], v15, s[24:27], s40 offen offset:2048
v_rcp_f32 v45, v45
v_mfma_f32_16x16x32_bf16 v[192:195], a[180:183], a[32:35], v[192:195]
ds_read_b128 a[0:3], v4 offset:45728
ds_read_b128 a[4:7], v4 offset:50336
v_mfma_f32_16x16x32_bf16 v[196:199], a[180:183], a[36:39], v[196:199]
ds_read_b128 a[8:11], v4 offset:54944
ds_read_b128 a[12:15], v4 offset:59552
v_mfma_f32_16x16x32_bf16 v[200:203], a[180:183], a[40:43], v[200:203]
v_rcp_f32_e64 v46, v46
v_mfma_f32_16x16x32_bf16 v[204:207], a[180:183], a[44:47], v[204:207]
buffer_load_dwordx4 a[252:255], v15, s[24:27], s40 offen offset:3072
v_rcp_f32_e64 v47, v47
v_mfma_f32_16x16x32_bf16 v[220:223], a[184:187], a[44:47], v[220:223]
v_fma_f32 v128, -v128, v40, v40
v_fma_f32 v129, -v129, v41, v41
v_fma_f32 v130, -v130, v42, v42
v_mfma_f32_16x16x32_bf16 v[216:219], a[184:187], a[40:43], v[216:219]
v_fma_f32 v131, -v131, v43, v43
v_fma_f32 v132, -v132, v44, v44
v_fma_f32 v133, -v133, v45, v45
v_mfma_f32_16x16x32_bf16 v[212:215], a[184:187], a[36:39], v[212:215]
v_fma_f32 v134, -v134, v46, v46
v_fma_f32 v135, -v135, v47, v47
v_cvt_pk_bf16_f32 v128, v128, v129
v_mfma_f32_16x16x32_bf16 v[208:211], a[184:187], a[32:35], v[208:211]
s_waitcnt vmcnt(15) lgkmcnt(4)
s_add_u32 s40, s40, 16384
buffer_load_dwordx4 a[72:75], v12, s[24:27], s40 offen offset:0
v_cvt_pk_bf16_f32 v129, v130, v131
v_cvt_pk_bf16_f32 v132, v132, v133
v_mfma_f32_16x16x32_bf16 v[192:195], a[188:191], a[48:51], v[192:195]
ds_read_b128 a[16:19], v4 offset:45792
ds_read_b128 a[20:23], v4 offset:50400
v_cvt_pk_bf16_f32 v133, v134, v135
v_mfma_f32_16x16x32_bf16 v[196:199], a[188:191], a[52:55], v[196:199]
ds_read_b128 a[24:27], v4 offset:55008
ds_read_b128 a[28:31], v4 offset:59616
v_mfma_f32_16x16x32_bf16 v[200:203], a[188:191], a[56:59], v[200:203]
ds_write_b64 v16, v[128:129] offset:20480
v_mfma_f32_16x16x32_bf16 v[204:207], a[188:191], a[60:63], v[204:207]
buffer_load_dwordx4 a[64:67], v12, s[24:27], s40 offen offset:1024
ds_write_b64 v16, v[132:133] offset:21760
v_mfma_f32_16x16x32_bf16 v[220:223], a[192:195], a[60:63], v[220:223]
v_min_f32 v136, s12, v136
v_min_f32 v137, s12, v137
v_min_f32 v138, s12, v138
v_mfma_f32_16x16x32_bf16 v[216:219], a[192:195], a[56:59], v[216:219]
v_min_f32 v139, s12, v139
v_min_f32 v140, s12, v140
v_min_f32_e64 v141, s12, v141
v_mfma_f32_16x16x32_bf16 v[212:215], a[192:195], a[52:55], v[212:215]
buffer_load_dwordx4 a[68:71], v12, s[24:27], s40 offen offset:2048
v_min_f32 v142, s12, v142
v_min_f32 v143, s12, v143
v_mfma_f32_16x16x32_bf16 v[208:211], a[192:195], a[48:51], v[208:211]
s_waitcnt vmcnt(16) lgkmcnt(6)
v_exp_f32 v152, v152
v_mfma_f32_16x16x32_bf16 v[192:195], a[196:199], a[0:3], v[192:195]
ds_read_b128 a[32:35], v2 offset:2272
ds_read_b128 a[36:39], v2 offset:6880
v_mfma_f32_16x16x32_bf16 v[196:199], a[196:199], a[4:7], v[196:199]
ds_read_b128 a[40:43], v2 offset:11488
ds_read_b128 a[44:47], v2 offset:16096
v_mfma_f32_16x16x32_bf16 v[200:203], a[196:199], a[8:11], v[200:203]
buffer_load_dwordx4 a[76:79], v12, s[24:27], s40 offen offset:3072
v_exp_f32_e64 v153, v153
v_mfma_f32_16x16x32_bf16 v[204:207], a[196:199], a[12:15], v[204:207]
v_exp_f32_e64 v154, v154
v_mfma_f32_16x16x32_bf16 v[220:223], a[200:203], a[12:15], v[220:223]
v_exp_f32_e64 v155, v155
v_mfma_f32_16x16x32_bf16 v[216:219], a[200:203], a[8:11], v[216:219]
v_exp_f32_e64 v156, v156
v_mfma_f32_16x16x32_bf16 v[212:215], a[200:203], a[4:7], v[212:215]
buffer_load_dwordx4 a[80:83], v13, s[24:27], s40 offen offset:0
v_exp_f32_e64 v157, v157
v_mfma_f32_16x16x32_bf16 v[208:211], a[200:203], a[0:3], v[208:211]
s_waitcnt vmcnt(16) lgkmcnt(6)
v_exp_f32 v158, v158
v_mfma_f32_16x16x32_bf16 v[192:195], a[204:207], a[16:19], v[192:195]
ds_read_b128 a[48:51], v2 offset:2336
ds_read_b128 a[52:55], v2 offset:6944
v_mfma_f32_16x16x32_bf16 v[208:211], a[208:211], a[16:19], v[208:211]
ds_read_b128 a[56:59], v2 offset:11552
ds_read_b128 a[60:63], v2 offset:16160
v_mfma_f32_16x16x32_bf16 v[196:199], a[204:207], a[20:23], v[196:199]
buffer_load_dwordx4 a[92:95], v13, s[24:27], s40 offen offset:1024
v_exp_f32_e64 v159, v159
v_mfma_f32_16x16x32_bf16 v[212:215], a[208:211], a[20:23], v[212:215]
v_exp_f32_e64 v136, v136
v_mfma_f32_16x16x32_bf16 v[200:203], a[204:207], a[24:27], v[200:203]
v_exp_f32_e64 v137, v137
v_mfma_f32_16x16x32_bf16 v[216:219], a[208:211], a[24:27], v[216:219]
buffer_load_dwordx4 a[84:87], v13, s[24:27], s40 offen offset:2048
v_exp_f32_e64 v138, v138
v_mfma_f32_16x16x32_bf16 v[204:207], a[204:207], a[28:31], v[204:207]
v_exp_f32_e64 v139, v139
v_mfma_f32_16x16x32_bf16 v[220:223], a[208:211], a[28:31], v[220:223]
s_waitcnt vmcnt(16) lgkmcnt(4)
v_exp_f32 v140, v140
v_mfma_f32_16x16x32_bf16 v[160:163], a[212:215], a[32:35], v[160:163]
ds_read_b128 a[0:3], v2 offset:2400
ds_read_b128 a[4:7], v2 offset:7008
v_mfma_f32_16x16x32_bf16 v[164:167], a[212:215], a[36:39], v[164:167]
buffer_load_dwordx4 a[88:91], v13, s[24:27], s40 offen offset:3072
ds_read_b128 a[8:11], v2 offset:11616
v_mfma_f32_16x16x32_bf16 v[168:171], a[212:215], a[40:43], v[168:171]
ds_read_b128 a[12:15], v2 offset:16224
v_exp_f32_e64 v141, v141
v_mfma_f32_16x16x32_bf16 v[172:175], a[212:215], a[44:47], v[172:175]
v_exp_f32_e64 v142, v142
v_mfma_f32_16x16x32_bf16 v[188:191], a[216:219], a[44:47], v[188:191]
v_exp_f32 v143, v143
v_add_f32 v40, 1.0, v136
v_mfma_f32_16x16x32_bf16 v[184:187], a[216:219], a[40:43], v[184:187]
buffer_load_dwordx4 a[96:99], v14, s[24:27], s40 offen offset:0
v_add_f32 v41, 1.0, v137
v_add_f32 v42, 1.0, v138
v_mfma_f32_16x16x32_bf16 v[180:183], a[216:219], a[36:39], v[180:183]
v_add_f32 v43, 1.0, v139
v_add_f32 v44, 1.0, v140
v_add_f32_e64 v45, 1.0, v141
v_mfma_f32_16x16x32_bf16 v[176:179], a[216:219], a[32:35], v[176:179]
s_waitcnt vmcnt(16) lgkmcnt(4)
v_add_f32 v46, 1.0, v142
v_add_f32_e64 v47, 1.0, v143
v_fma_f32 v40, v40, v152, v40
v_mfma_f32_16x16x32_bf16 v[160:163], a[220:223], a[48:51], v[160:163]
ds_read_b128 a[16:19], v2 offset:2464
ds_read_b128 a[20:23], v2 offset:7072
v_fma_f32 v41, v41, v153, v41
v_mfma_f32_16x16x32_bf16 v[164:167], a[220:223], a[52:55], v[164:167]
buffer_load_dwordx4 a[100:103], v14, s[24:27], s40 offen offset:1024
ds_read_b128 a[24:27], v2 offset:11680
v_fma_f32 v42, v42, v154, v42
v_mfma_f32_16x16x32_bf16 v[168:171], a[220:223], a[56:59], v[168:171]
ds_read_b128 a[28:31], v2 offset:16288
v_fma_f32 v43, v43, v155, v43
v_fma_f32 v44, v44, v156, v44
v_mfma_f32_16x16x32_bf16 v[172:175], a[220:223], a[60:63], v[172:175]
v_fma_f32 v45, v45, v157, v45
v_fma_f32 v46, v46, v158, v46
v_fma_f32 v47, v47, v159, v47
v_mfma_f32_16x16x32_bf16 v[188:191], a[224:227], a[60:63], v[188:191]
buffer_load_dwordx4 a[112:115], v14, s[24:27], s40 offen offset:2048
v_rcp_f32_e64 v40, v40
v_mfma_f32_16x16x32_bf16 v[184:187], a[224:227], a[56:59], v[184:187]
v_rcp_f32_e64 v41, v41
v_mfma_f32_16x16x32_bf16 v[180:183], a[224:227], a[52:55], v[180:183]
v_rcp_f32_e64 v42, v42
v_mfma_f32_16x16x32_bf16 v[176:179], a[224:227], a[48:51], v[176:179]
s_waitcnt vmcnt(16) lgkmcnt(4)
v_rcp_f32 v43, v43
v_mfma_f32_16x16x32_bf16 v[160:163], a[228:231], a[0:3], v[160:163]
buffer_load_dwordx4 a[132:135], v14, s[24:27], s40 offen offset:3072
ds_read_b128 a[32:35], v3 offset:0
v_mfma_f32_16x16x32_bf16 v[164:167], a[228:231], a[4:7], v[164:167]
ds_read_b128 a[36:39], v3 offset:4608
ds_read_b128 a[40:43], v3 offset:9216
v_mfma_f32_16x16x32_bf16 v[168:171], a[228:231], a[8:11], v[168:171]
ds_read_b128 a[44:47], v3 offset:13824
v_rcp_f32_e64 v44, v44
v_mfma_f32_16x16x32_bf16 v[172:175], a[228:231], a[12:15], v[172:175]
v_rcp_f32_e64 v45, v45
v_mfma_f32_16x16x32_bf16 v[188:191], a[232:235], a[12:15], v[188:191]
buffer_load_dwordx4 a[152:155], v15, s[24:27], s40 offen offset:0
v_rcp_f32_e64 v46, v46
v_mfma_f32_16x16x32_bf16 v[184:187], a[232:235], a[8:11], v[184:187]
v_rcp_f32_e64 v47, v47
v_fma_f32 v136, -v136, v40, v40
v_mfma_f32_16x16x32_bf16 v[180:183], a[232:235], a[4:7], v[180:183]
v_fma_f32 v137, -v137, v41, v41
v_fma_f32 v138, -v138, v42, v42
v_fma_f32 v139, -v139, v43, v43
v_mfma_f32_16x16x32_bf16 v[176:179], a[232:235], a[0:3], v[176:179]
s_waitcnt vmcnt(16) lgkmcnt(4)
v_fma_f32 v140, -v140, v44, v44
v_fma_f32 v141, -v141, v45, v45
v_fma_f32 v142, -v142, v46, v46
v_mfma_f32_16x16x32_bf16 v[160:163], a[236:239], a[16:19], v[160:163]
buffer_load_dwordx4 a[104:107], v15, s[24:27], s40 offen offset:1024
ds_read_b128 a[48:51], v2 offset:0
v_fma_f32 v143, -v143, v47, v47
v_mfma_f32_16x16x32_bf16 v[164:167], a[236:239], a[20:23], v[164:167]
ds_read_b128 a[52:55], v2 offset:4608
ds_read_b128 a[56:59], v2 offset:9216
v_cvt_pk_bf16_f32 v136, v136, v137
v_mfma_f32_16x16x32_bf16 v[168:171], a[236:239], a[24:27], v[168:171]
ds_read_b128 a[60:63], v2 offset:13824
v_cvt_pk_bf16_f32 v137, v138, v139
v_cvt_pk_bf16_f32 v140, v140, v141
v_mfma_f32_16x16x32_bf16 v[172:175], a[236:239], a[28:31], v[172:175]
buffer_load_dwordx4 a[108:111], v15, s[24:27], s40 offen offset:2048
v_cvt_pk_bf16_f32 v141, v142, v143
v_mfma_f32_16x16x32_bf16 v[188:191], a[240:243], a[28:31], v[188:191]
ds_write_b64 v16, v[136:137] offset:25600
v_mfma_f32_16x16x32_bf16 v[184:187], a[240:243], a[24:27], v[184:187]
ds_write_b64 v16, v[140:141] offset:26880
v_permlane32_swap_b32 v112, v116
v_mfma_f32_16x16x32_bf16 v[180:183], a[240:243], a[20:23], v[180:183]
v_permlane32_swap_b32 v113, v117
v_permlane32_swap_b32 v114, v118
v_permlane32_swap_b32 v115, v119
v_mfma_f32_16x16x32_bf16 v[176:179], a[240:243], a[16:19], v[176:179]
s_waitcnt vmcnt(16) lgkmcnt(6)
buffer_load_dwordx4 a[116:119], v15, s[24:27], s40 offen offset:3072
v_permlane32_swap_b32 v120, v124
v_permlane32_swap_b32 v121, v125
v_mfma_f32_16x16x32_bf16 v[160:163], a[244:247], a[32:35], v[160:163]
ds_read_b128 a[0:3], v2 offset:64
ds_read_b128 a[4:7], v2 offset:4672
v_permlane32_swap_b32 v122, v126
v_mfma_f32_16x16x32_bf16 v[164:167], a[244:247], a[36:39], v[164:167]
ds_read_b128 a[8:11], v2 offset:9280
ds_read_b128 a[12:15], v2 offset:13888
v_permlane32_swap_b32 v123, v127
v_mfma_f32_16x16x32_bf16 v[168:171], a[244:247], a[40:43], v[168:171]
v_min_f32 v112, s12, v112
v_min_f32 v113, s12, v113
v_min_f32_e64 v114, s12, v114
v_mfma_f32_16x16x32_bf16 v[172:175], a[244:247], a[44:47], v[172:175]
s_add_u32 s40, s40, 16384
buffer_load_dwordx4 a[120:123], v12, s[24:27], s40 offen offset:0
v_min_f32 v115, s12, v115
v_min_f32 v120, s12, v120
v_mfma_f32_16x16x32_bf16 v[188:191], a[248:251], a[44:47], v[188:191]
v_min_f32 v121, s12, v121
v_min_f32 v122, s12, v122
v_min_f32_e64 v123, s12, v123
v_mfma_f32_16x16x32_bf16 v[184:187], a[248:251], a[40:43], v[184:187]
v_exp_f32_e64 v116, v116
v_mfma_f32_16x16x32_bf16 v[180:183], a[248:251], a[36:39], v[180:183]
v_exp_f32_e64 v117, v117
v_mfma_f32_16x16x32_bf16 v[176:179], a[248:251], a[32:35], v[176:179]
s_waitcnt vmcnt(16) lgkmcnt(6)
buffer_load_dwordx4 a[124:127], v12, s[24:27], s40 offen offset:1024
v_exp_f32 v118, v118
v_mfma_f32_16x16x32_bf16 v[160:163], a[252:255], a[48:51], v[160:163]
ds_read_b128 a[16:19], v2 offset:128
ds_read_b128 a[20:23], v2 offset:4736
v_mfma_f32_16x16x32_bf16 v[164:167], a[252:255], a[52:55], v[164:167]
ds_read_b128 a[24:27], v2 offset:9344
ds_read_b128 a[28:31], v2 offset:13952
v_mfma_f32_16x16x32_bf16 v[168:171], a[252:255], a[56:59], v[168:171]
buffer_load_dwordx4 a[128:131], v12, s[24:27], s40 offen offset:2048
v_exp_f32_e64 v119, v119
v_mfma_f32_16x16x32_bf16 v[172:175], a[252:255], a[60:63], v[172:175]
v_exp_f32_e64 v124, v124
v_mfma_f32_16x16x32_bf16 v[188:191], a[72:75], a[60:63], v[188:191]
v_exp_f32_e64 v125, v125
v_mfma_f32_16x16x32_bf16 v[184:187], a[72:75], a[56:59], v[184:187]
v_exp_f32_e64 v126, v126
v_mfma_f32_16x16x32_bf16 v[180:183], a[72:75], a[52:55], v[180:183]
buffer_load_dwordx4 a[136:139], v12, s[24:27], s40 offen offset:3072
v_exp_f32_e64 v127, v127
v_mfma_f32_16x16x32_bf16 v[176:179], a[72:75], a[48:51], v[176:179]
s_waitcnt vmcnt(17) lgkmcnt(4)
v_exp_f32 v112, v112
v_mfma_f32_16x16x32_bf16 v[160:163], a[64:67], a[0:3], v[160:163]
ds_read_b128 a[32:35], v2 offset:192
ds_read_b128 a[36:39], v2 offset:4800
v_mfma_f32_16x16x32_bf16 v[164:167], a[64:67], a[4:7], v[164:167]
ds_read_b128 a[40:43], v2 offset:9408
ds_read_b128 a[44:47], v2 offset:14016
v_mfma_f32_16x16x32_bf16 v[168:171], a[64:67], a[8:11], v[168:171]
buffer_load_dwordx4 a[140:143], v13, s[24:27], s40 offen offset:0
v_exp_f32_e64 v113, v113
v_mfma_f32_16x16x32_bf16 v[172:175], a[64:67], a[12:15], v[172:175]
v_exp_f32_e64 v114, v114
v_mfma_f32_16x16x32_bf16 v[188:191], a[68:71], a[12:15], v[188:191]
v_exp_f32_e64 v115, v115
v_mfma_f32_16x16x32_bf16 v[184:187], a[68:71], a[8:11], v[184:187]
v_exp_f32_e64 v120, v120
v_mfma_f32_16x16x32_bf16 v[180:183], a[68:71], a[4:7], v[180:183]
buffer_load_dwordx4 a[144:147], v13, s[24:27], s40 offen offset:1024
v_exp_f32_e64 v121, v121
v_mfma_f32_16x16x32_bf16 v[176:179], a[68:71], a[0:3], v[176:179]
s_waitcnt vmcnt(17) lgkmcnt(4)
v_exp_f32 v122, v122
v_mfma_f32_16x16x32_bf16 v[160:163], a[76:79], a[16:19], v[160:163]
ds_read_b128 a[48:51], v4 offset:2272
ds_read_b128 a[52:55], v4 offset:6880
v_mfma_f32_16x16x32_bf16 v[164:167], a[76:79], a[20:23], v[164:167]
buffer_load_dwordx4 a[148:151], v13, s[24:27], s40 offen offset:2048
ds_read_b128 a[56:59], v4 offset:11488
v_mfma_f32_16x16x32_bf16 v[168:171], a[76:79], a[24:27], v[168:171]
ds_read_b128 a[60:63], v4 offset:16096
v_exp_f32_e64 v123, v123
v_mfma_f32_16x16x32_bf16 v[172:175], a[76:79], a[28:31], v[172:175]
v_add_f32 v96, 1.0, v112
v_add_f32 v97, 1.0, v113
v_add_f32_e64 v98, 1.0, v114
v_mfma_f32_16x16x32_bf16 v[188:191], a[80:83], a[28:31], v[188:191]
v_add_f32 v99, 1.0, v115
v_add_f32 v100, 1.0, v120
v_add_f32_e64 v101, 1.0, v121
v_mfma_f32_16x16x32_bf16 v[184:187], a[80:83], a[24:27], v[184:187]
buffer_load_dwordx4 a[156:159], v13, s[24:27], s40 offen offset:3072
v_add_f32 v102, 1.0, v122
v_add_f32 v103, 1.0, v123
v_mfma_f32_16x16x32_bf16 v[180:183], a[80:83], a[20:23], v[180:183]
v_fma_f32 v96, v96, v116, v96
v_fma_f32 v97, v97, v117, v97
v_fma_f32 v98, v98, v118, v98
v_mfma_f32_16x16x32_bf16 v[176:179], a[80:83], a[16:19], v[176:179]
s_waitcnt vmcnt(17) lgkmcnt(4)
v_fma_f32 v99, v99, v119, v99
v_fma_f32 v100, v100, v124, v100
v_fma_f32 v101, v101, v125, v101
v_mfma_f32_16x16x32_bf16 v[160:163], a[92:95], a[32:35], v[160:163]
ds_read_b128 a[0:3], v4 offset:2336
ds_read_b128 a[4:7], v4 offset:6944
v_fma_f32 v102, v102, v126, v102
v_mfma_f32_16x16x32_bf16 v[164:167], a[92:95], a[36:39], v[164:167]
buffer_load_dwordx4 a[160:163], v14, s[24:27], s40 offen offset:0
ds_read_b128 a[8:11], v4 offset:11552
v_fma_f32 v103, v103, v127, v103
v_mfma_f32_16x16x32_bf16 v[168:171], a[92:95], a[40:43], v[168:171]
ds_read_b128 a[12:15], v4 offset:16160
v_rcp_f32 v96, v96
v_mfma_f32_16x16x32_bf16 v[172:175], a[92:95], a[44:47], v[172:175]
v_rcp_f32_e64 v97, v97
v_mfma_f32_16x16x32_bf16 v[188:191], a[84:87], a[44:47], v[188:191]
v_rcp_f32_e64 v98, v98
v_mfma_f32_16x16x32_bf16 v[184:187], a[84:87], a[40:43], v[184:187]
buffer_load_dwordx4 a[164:167], v14, s[24:27], s40 offen offset:1024
v_rcp_f32_e64 v99, v99
v_mfma_f32_16x16x32_bf16 v[180:183], a[84:87], a[36:39], v[180:183]
v_rcp_f32_e64 v100, v100
v_mfma_f32_16x16x32_bf16 v[176:179], a[84:87], a[32:35], v[176:179]
s_waitcnt vmcnt(17) lgkmcnt(4)
v_rcp_f32 v101, v101
v_mfma_f32_16x16x32_bf16 v[224:227], a[88:91], a[48:51], v[224:227]
buffer_load_dwordx4 a[168:171], v14, s[24:27], s40 offen offset:2048
ds_read_b128 a[16:19], v4 offset:2400
v_fmac_f32_e64 v236, s10, v172
v_mfma_f32_16x16x32_bf16 v[228:231], a[88:91], a[52:55], v[228:231]
ds_read_b128 a[20:23], v4 offset:7008
ds_read_b128 a[24:27], v4 offset:11616
v_fmac_f32_e64 v240, s10, v176
v_mfma_f32_16x16x32_bf16 v[232:235], a[88:91], a[56:59], v[232:235]
ds_read_b128 a[28:31], v4 offset:16224
v_rcp_f32_e64 v102, v102
v_mfma_f32_16x16x32_bf16 v[236:239], a[88:91], a[60:63], v[236:239]
v_rcp_f32_e64 v103, v103
v_fma_f32 v112, -v112, v96, v96
v_mfma_f32_16x16x32_bf16 v[252:255], a[96:99], a[60:63], v[252:255]
buffer_load_dwordx4 a[172:175], v14, s[24:27], s40 offen offset:3072
v_fma_f32 v113, -v113, v97, v97
v_fma_f32 v114, -v114, v98, v98
v_mfma_f32_16x16x32_bf16 v[248:251], a[96:99], a[56:59], v[248:251]
v_fma_f32 v115, -v115, v99, v99
v_fma_f32 v120, -v120, v100, v100
v_fma_f32 v121, -v121, v101, v101
v_mfma_f32_16x16x32_bf16 v[244:247], a[96:99], a[52:55], v[244:247]
v_fma_f32 v122, -v122, v102, v102
v_fma_f32 v123, -v123, v103, v103
v_cvt_pk_bf16_f32 v112, v112, v113
v_mfma_f32_16x16x32_bf16 v[240:243], a[96:99], a[48:51], v[240:243]
s_waitcnt vmcnt(17) lgkmcnt(4)
v_cvt_pk_bf16_f32 v113, v114, v115
v_cvt_pk_bf16_f32 v120, v120, v121
v_cvt_pk_bf16_f32 v121, v122, v123
v_mfma_f32_16x16x32_bf16 v[224:227], a[100:103], a[0:3], v[224:227]
buffer_load_dwordx4 a[176:179], v15, s[24:27], s40 offen offset:0
ds_read_b128 a[32:35], v4 offset:2464
v_fmac_f32 v237, s10, v173
v_mfma_f32_16x16x32_bf16 v[228:231], a[100:103], a[4:7], v[228:231]
ds_read_b128 a[36:39], v4 offset:7072
ds_read_b128 a[40:43], v4 offset:11680
v_fmac_f32_e64 v241, s10, v177
v_mfma_f32_16x16x32_bf16 v[232:235], a[100:103], a[8:11], v[232:235]
ds_read_b128 a[44:47], v4 offset:16288
ds_write_b64 v18, v[112:113] offset:0
v_mfma_f32_16x16x32_bf16 v[236:239], a[100:103], a[12:15], v[236:239]
ds_write_b64 v18, v[120:121] offset:5120
v_add_u32_e64 v96, v92, v19
v_mfma_f32_16x16x32_bf16 v[252:255], a[112:115], a[12:15], v[252:255]
buffer_load_dwordx4 a[180:183], v15, s[24:27], s40 offen offset:1024
v_add_u32 v97, v93, v19
v_min_f32 v192, s12, v192
v_mfma_f32_16x16x32_bf16 v[248:251], a[112:115], a[8:11], v[248:251]
v_min_f32 v193, s12, v193
v_min_f32 v194, s12, v194
v_min_f32_e64 v195, s12, v195
v_mfma_f32_16x16x32_bf16 v[244:247], a[112:115], a[4:7], v[244:247]
v_min_f32 v196, s12, v196
v_min_f32 v197, s12, v197
v_min_f32_e64 v198, s12, v198
v_mfma_f32_16x16x32_bf16 v[240:243], a[112:115], a[0:3], v[240:243]
s_waitcnt vmcnt(17) lgkmcnt(6)
buffer_load_dwordx4 a[184:187], v15, s[24:27], s40 offen offset:2048
v_min_f32 v199, s12, v199
v_fmac_f32_e64 v232, s10, v168
v_mfma_f32_16x16x32_bf16 v[224:227], a[132:135], a[16:19], v[224:227]
ds_read_b128 a[48:51], v5 offset:0
ds_read_b128 a[52:55], v5 offset:4608
v_fmac_f32_e64 v238, s10, v174
v_mfma_f32_16x16x32_bf16 v[228:231], a[132:135], a[20:23], v[228:231]
ds_read_b128 a[56:59], v5 offset:9216
ds_read_b128 a[60:63], v5 offset:13824
v_fmac_f32_e64 v242, s10, v178
v_mfma_f32_16x16x32_bf16 v[232:235], a[132:135], a[24:27], v[232:235]
v_exp_f32 v208, v208
v_fmac_f32 v224, s10, v160
v_mfma_f32_16x16x32_bf16 v[236:239], a[132:135], a[28:31], v[236:239]
buffer_load_dwordx4 a[188:191], v15, s[24:27], s40 offen offset:3072
v_exp_f32_e64 v209, v209
v_mfma_f32_16x16x32_bf16 v[252:255], a[152:155], a[28:31], v[252:255]
v_exp_f32 v210, v210
v_fmac_f32 v225, s10, v161
v_mfma_f32_16x16x32_bf16 v[248:251], a[152:155], a[24:27], v[248:251]
v_exp_f32 v211, v211
v_fmac_f32 v226, s10, v162
v_mfma_f32_16x16x32_bf16 v[244:247], a[152:155], a[20:23], v[244:247]
v_exp_f32 v212, v212
v_fmac_f32 v228, s10, v164
v_mfma_f32_16x16x32_bf16 v[240:243], a[152:155], a[16:19], v[240:243]
s_waitcnt vmcnt(17) lgkmcnt(6)
s_add_u32 s40, s40, 16384
buffer_load_dwordx4 a[192:195], v12, s[24:27], s40 offen offset:0
v_exp_f32 v213, v213
v_mfma_f32_16x16x32_bf16 v[224:227], a[104:107], a[32:35], v[224:227]
ds_read_b128 a[0:3], v4 offset:0
ds_read_b128 a[4:7], v4 offset:4608
v_fmac_f32_e64 v239, s10, v175
v_mfma_f32_16x16x32_bf16 v[228:231], a[104:107], a[36:39], v[228:231]
ds_read_b128 a[8:11], v4 offset:9216
ds_read_b128 a[12:15], v4 offset:13824
v_fmac_f32_e64 v243, s10, v179
v_mfma_f32_16x16x32_bf16 v[232:235], a[104:107], a[40:43], v[232:235]
v_exp_f32 v214, v214
v_fmac_f32 v227, s10, v163
v_mfma_f32_16x16x32_bf16 v[236:239], a[104:107], a[44:47], v[236:239]
buffer_load_dwordx4 a[196:199], v12, s[24:27], s40 offen offset:1024
v_exp_f32_e64 v215, v215
v_mfma_f32_16x16x32_bf16 v[252:255], a[108:111], a[44:47], v[252:255]
v_exp_f32 v192, v192
v_fmac_f32 v229, s10, v165
v_mfma_f32_16x16x32_bf16 v[248:251], a[108:111], a[40:43], v[248:251]
v_exp_f32 v193, v193
v_fmac_f32 v230, s10, v166
v_mfma_f32_16x16x32_bf16 v[244:247], a[108:111], a[36:39], v[244:247]
buffer_load_dwordx4 a[200:203], v12, s[24:27], s40 offen offset:2048
v_exp_f32_e64 v194, v194
v_mfma_f32_16x16x32_bf16 v[240:243], a[108:111], a[32:35], v[240:243]
s_waitcnt vmcnt(18) lgkmcnt(4)
v_exp_f32 v195, v195
v_fmac_f32_e64 v233, s10, v169
v_mfma_f32_16x16x32_bf16 v[224:227], a[116:119], a[48:51], v[224:227]
ds_read_b128 a[16:19], v4 offset:64
ds_read_b128 a[20:23], v4 offset:4672
v_fmac_f32_e64 v244, s10, v180
v_mfma_f32_16x16x32_bf16 v[228:231], a[116:119], a[52:55], v[228:231]
ds_read_b128 a[24:27], v4 offset:9280
ds_read_b128 a[28:31], v4 offset:13888
v_fmac_f32_e64 v245, s10, v181
v_mfma_f32_16x16x32_bf16 v[232:235], a[116:119], a[56:59], v[232:235]
buffer_load_dwordx4 a[204:207], v12, s[24:27], s40 offen offset:3072
v_exp_f32_e64 v196, v196
v_mfma_f32_16x16x32_bf16 v[236:239], a[116:119], a[60:63], v[236:239]
v_exp_f32 v197, v197
v_fmac_f32 v231, s10, v167
v_mfma_f32_16x16x32_bf16 v[252:255], a[120:123], a[60:63], v[252:255]
L_isl6:
s_cbranch_execz L_wret
v_exp_f32 v198, v198
v_mfma_f32_16x16x32_bf16 v[248:251], a[120:123], a[56:59], v[248:251]
v_exp_f32 v199, v199
v_add_f32 v40, 1.0, v192
v_mfma_f32_16x16x32_bf16 v[244:247], a[120:123], a[52:55], v[244:247]
buffer_load_dwordx4 a[208:211], v13, s[24:27], s40 offen offset:0
v_add_f32 v41, 1.0, v193
v_add_f32 v42, 1.0, v194
v_mfma_f32_16x16x32_bf16 v[240:243], a[120:123], a[48:51], v[240:243]
s_waitcnt vmcnt(18) lgkmcnt(4)
v_add_f32 v43, 1.0, v195
v_add_f32 v44, 1.0, v196
v_add_f32 v45, 1.0, v197
v_mfma_f32_16x16x32_bf16 v[224:227], a[124:127], a[0:3], v[224:227]
ds_read_b128 a[32:35], v4 offset:128
ds_read_b128 a[36:39], v4 offset:4736
v_add_f32_e64 v46, 1.0, v198
v_mfma_f32_16x16x32_bf16 v[228:231], a[124:127], a[4:7], v[228:231]
ds_read_b128 a[40:43], v4 offset:9344
ds_read_b128 a[44:47], v4 offset:13952
v_add_f32_e64 v47, 1.0, v199
v_mfma_f32_16x16x32_bf16 v[232:235], a[124:127], a[8:11], v[232:235]
buffer_load_dwordx4 a[212:215], v13, s[24:27], s40 offen offset:1024
v_fma_f32 v40, v40, v208, v40
v_fma_f32 v41, v41, v209, v41
v_mfma_f32_16x16x32_bf16 v[236:239], a[124:127], a[12:15], v[236:239]
v_fma_f32 v42, v42, v210, v42
v_fma_f32 v43, v43, v211, v43
v_fma_f32 v44, v44, v212, v44
v_mfma_f32_16x16x32_bf16 v[252:255], a[128:131], a[12:15], v[252:255]
v_fma_f32 v45, v45, v213, v45
v_fma_f32 v46, v46, v214, v46
v_fma_f32 v47, v47, v215, v47
v_mfma_f32_16x16x32_bf16 v[248:251], a[128:131], a[8:11], v[248:251]
buffer_load_dwordx4 a[216:219], v13, s[24:27], s40 offen offset:2048
v_rcp_f32_e64 v40, v40
v_mfma_f32_16x16x32_bf16 v[244:247], a[128:131], a[4:7], v[244:247]
v_rcp_f32 v41, v41
v_fmac_f32 v234, s10, v170
v_mfma_f32_16x16x32_bf16 v[240:243], a[128:131], a[0:3], v[240:243]
s_waitcnt vmcnt(18) lgkmcnt(4)
v_rcp_f32 v42, v42
v_fmac_f32_e64 v235, s10, v171
v_mfma_f32_16x16x32_bf16 v[224:227], a[136:139], a[16:19], v[224:227]
ds_read_b128 a[48:51], v4 offset:192
ds_read_b128 a[52:55], v4 offset:4800
v_fmac_f32_e64 v246, s10, v182
v_mfma_f32_16x16x32_bf16 v[228:231], a[136:139], a[20:23], v[228:231]
buffer_load_dwordx4 a[220:223], v13, s[24:27], s40 offen offset:3072
ds_read_b128 a[56:59], v4 offset:9408
v_fmac_f32_e64 v247, s10, v183
v_mfma_f32_16x16x32_bf16 v[232:235], a[136:139], a[24:27], v[232:235]
ds_read_b128 a[60:63], v4 offset:14016
v_rcp_f32_e64 v43, v43
v_mfma_f32_16x16x32_bf16 v[236:239], a[136:139], a[28:31], v[236:239]
v_rcp_f32_e64 v44, v44
v_mfma_f32_16x16x32_bf16 v[252:255], a[140:143], a[28:31], v[252:255]
v_rcp_f32_e64 v45, v45
v_mfma_f32_16x16x32_bf16 v[248:251], a[140:143], a[24:27], v[248:251]
buffer_load_dwordx4 a[224:227], v14, s[24:27], s40 offen offset:0
v_rcp_f32_e64 v46, v46
v_mfma_f32_16x16x32_bf16 v[244:247], a[140:143], a[20:23], v[244:247]
v_rcp_f32_e64 v47, v47
v_fma_f32 v192, -v192, v40, v40
v_mfma_f32_16x16x32_bf16 v[240:243], a[140:143], a[16:19], v[240:243]
s_waitcnt vmcnt(18) lgkmcnt(4)
v_fmac_f32 v252, s10, v188
v_fmac_f32 v253, s10, v189
v_fmac_f32 v254, s10, v190
v_mfma_f32_16x16x32_bf16 v[224:227], a[144:147], a[32:35], v[224:227]
ds_read_b128 a[0:3], v2 offset:47872
ds_read_b128 a[4:7], v2 offset:52480
v_fmac_f32_e64 v248, s10, v184
v_mfma_f32_16x16x32_bf16 v[228:231], a[144:147], a[36:39], v[228:231]
buffer_load_dwordx4 a[228:231], v14, s[24:27], s40 offen offset:1024
ds_read_b128 a[8:11], v2 offset:57088
v_fmac_f32_e64 v249, s10, v185
v_mfma_f32_16x16x32_bf16 v[232:235], a[144:147], a[40:43], v[232:235]
ds_read_b128 a[12:15], v2 offset:61696
v_fmac_f32 v250, s10, v186
v_fmac_f32 v251, s10, v187
v_mfma_f32_16x16x32_bf16 v[236:239], a[144:147], a[44:47], v[236:239]
v_fma_f32 v193, -v193, v41, v41
v_fma_f32 v194, -v194, v42, v42
v_fma_f32 v195, -v195, v43, v43
v_mfma_f32_16x16x32_bf16 v[252:255], a[148:151], a[44:47], v[252:255]
buffer_load_dwordx4 a[232:235], v14, s[24:27], s40 offen offset:2048
v_fma_f32 v196, -v196, v44, v44
v_fma_f32 v197, -v197, v45, v45
v_mfma_f32_16x16x32_bf16 v[248:251], a[148:151], a[40:43], v[248:251]
v_fma_f32 v198, -v198, v46, v46
v_fma_f32 v199, -v199, v47, v47
v_cvt_pk_bf16_f32 v192, v192, v193
v_mfma_f32_16x16x32_bf16 v[244:247], a[148:151], a[36:39], v[244:247]
v_fmac_f32_e64 v255, s10, v191
v_cvt_pk_bf16_f32 v193, v194, v195
v_cvt_pk_bf16_f32 v196, v196, v197
v_mfma_f32_16x16x32_bf16 v[240:243], a[148:151], a[32:35], v[240:243]
s_waitcnt vmcnt(18) lgkmcnt(4)
v_cvt_pk_bf16_f32 v197, v198, v199
ds_write_b64 v17, v[192:193] offset:20480
v_mfma_f32_16x16x32_bf16 v[224:227], a[156:159], a[48:51], v[224:227]
buffer_load_dwordx4 a[236:239], v14, s[24:27], s40 offen offset:3072
ds_read_b128 a[16:19], v2 offset:47936
v_mfma_f32_16x16x32_bf16 v[228:231], a[156:159], a[52:55], v[228:231]
ds_read_b128 a[20:23], v2 offset:52544
ds_read_b128 a[24:27], v2 offset:57152
v_mfma_f32_16x16x32_bf16 v[232:235], a[156:159], a[56:59], v[232:235]
ds_read_b128 a[28:31], v2 offset:61760
ds_write_b64 v17, v[196:197] offset:21760
v_mfma_f32_16x16x32_bf16 v[236:239], a[156:159], a[60:63], v[236:239]
v_min_f32 v200, s12, v200
v_min_f32 v201, s12, v201
v_min_f32 v202, s12, v202
v_mfma_f32_16x16x32_bf16 v[252:255], a[160:163], a[60:63], v[252:255]
buffer_load_dwordx4 a[240:243], v15, s[24:27], s40 offen offset:0
v_min_f32 v203, s12, v203
v_min_f32 v204, s12, v204
v_mfma_f32_16x16x32_bf16 v[248:251], a[160:163], a[56:59], v[248:251]
v_min_f32 v205, s12, v205
v_min_f32 v206, s12, v206
v_min_f32_e64 v207, s12, v207
v_mfma_f32_16x16x32_bf16 v[244:247], a[160:163], a[52:55], v[244:247]
v_exp_f32_e64 v216, v216
v_mfma_f32_16x16x32_bf16 v[240:243], a[160:163], a[48:51], v[240:243]
s_waitcnt vmcnt(18) lgkmcnt(6)
v_exp_f32 v217, v217
v_mfma_f32_16x16x32_bf16 v[160:163], a[164:167], a[0:3], v[160:163]
buffer_load_dwordx4 a[244:247], v15, s[24:27], s40 offen offset:1024
ds_read_b128 a[32:35], v2 offset:48000
v_fmac_f32_e64 v172, s11, v236
v_mfma_f32_16x16x32_bf16 v[164:167], a[164:167], a[4:7], v[164:167]
ds_read_b128 a[36:39], v2 offset:52608
ds_read_b128 a[40:43], v2 offset:57216
v_fmac_f32_e64 v176, s11, v240
v_mfma_f32_16x16x32_bf16 v[168:171], a[164:167], a[8:11], v[168:171]
ds_read_b128 a[44:47], v2 offset:61824
v_exp_f32_e64 v218, v218
v_mfma_f32_16x16x32_bf16 v[172:175], a[164:167], a[12:15], v[172:175]
buffer_load_dwordx4 a[248:251], v15, s[24:27], s40 offen offset:2048
v_exp_f32_e64 v219, v219
v_mfma_f32_16x16x32_bf16 v[188:191], a[168:171], a[12:15], v[188:191]
v_exp_f32 v220, v220
v_fmac_f32 v160, s11, v224
v_mfma_f32_16x16x32_bf16 v[184:187], a[168:171], a[8:11], v[184:187]
v_exp_f32 v221, v221
v_fmac_f32 v161, s11, v225
v_mfma_f32_16x16x32_bf16 v[180:183], a[168:171], a[4:7], v[180:183]
v_exp_f32 v222, v222
v_fmac_f32 v164, s11, v228
v_mfma_f32_16x16x32_bf16 v[176:179], a[168:171], a[0:3], v[176:179]
s_waitcnt vmcnt(18) lgkmcnt(5)
buffer_load_dwordx4 a[252:255], v15, s[24:27], s40 offen offset:3072
v_exp_f32 v223, v223
v_mfma_f32_16x16x32_bf16 v[160:163], a[172:175], a[16:19], v[160:163]
ds_read_b128 a[48:51], v2 offset:48064
ds_read_b128 a[52:55], v2 offset:52672
v_fmac_f32_e64 v173, s11, v237
v_mfma_f32_16x16x32_bf16 v[164:167], a[172:175], a[20:23], v[164:167]
ds_read_b128 a[56:59], v2 offset:57280
ds_read_b128 a[60:63], v2 offset:61888
v_fmac_f32_e64 v177, s11, v241
v_mfma_f32_16x16x32_bf16 v[168:171], a[172:175], a[24:27], v[168:171]
v_exp_f32 v200, v200
v_fmac_f32 v162, s11, v226
v_mfma_f32_16x16x32_bf16 v[172:175], a[172:175], a[28:31], v[172:175]
s_add_u32 s40, s40, 16384
buffer_load_dwordx4 a[72:75], v12, s[24:27], s40 offen offset:0
v_exp_f32_e64 v201, v201
v_mfma_f32_16x16x32_bf16 v[188:191], a[176:179], a[28:31], v[188:191]
v_exp_f32 v202, v202
v_fmac_f32 v163, s11, v227
v_mfma_f32_16x16x32_bf16 v[184:187], a[176:179], a[24:27], v[184:187]
v_exp_f32 v203, v203
v_fmac_f32 v165, s11, v229
v_mfma_f32_16x16x32_bf16 v[180:183], a[176:179], a[20:23], v[180:183]
v_exp_f32 v204, v204
v_fmac_f32 v166, s11, v230
v_mfma_f32_16x16x32_bf16 v[176:179], a[176:179], a[16:19], v[176:179]
s_waitcnt vmcnt(18) lgkmcnt(4)
buffer_load_dwordx4 a[92:95], v12, s[24:27], s40 offen offset:1024
v_exp_f32 v205, v205
v_mfma_f32_16x16x32_bf16 v[160:163], a[180:183], a[32:35], v[160:163]
ds_read_b128 a[0:3], v3 offset:45600
ds_read_b128 a[4:7], v3 offset:50208
v_fmac_f32_e64 v174, s11, v238
v_mfma_f32_16x16x32_bf16 v[164:167], a[180:183], a[36:39], v[164:167]
ds_read_b128 a[8:11], v3 offset:54816
ds_read_b128 a[12:15], v3 offset:59424
v_fmac_f32_e64 v178, s11, v242
v_mfma_f32_16x16x32_bf16 v[168:171], a[180:183], a[40:43], v[168:171]
buffer_load_dwordx4 a[88:91], v12, s[24:27], s40 offen offset:2048
v_exp_f32_e64 v206, v206
v_mfma_f32_16x16x32_bf16 v[172:175], a[180:183], a[44:47], v[172:175]
v_exp_f32 v207, v207
v_add_f32 v40, 1.0, v200
v_mfma_f32_16x16x32_bf16 v[188:191], a[184:187], a[44:47], v[188:191]
v_add_f32 v41, 1.0, v201
v_add_f32 v42, 1.0, v202
v_add_f32_e64 v43, 1.0, v203
v_mfma_f32_16x16x32_bf16 v[184:187], a[184:187], a[40:43], v[184:187]
v_add_f32 v44, 1.0, v204
v_add_f32 v45, 1.0, v205
v_add_f32_e64 v46, 1.0, v206
v_mfma_f32_16x16x32_bf16 v[180:183], a[184:187], a[36:39], v[180:183]
buffer_load_dwordx4 a[96:99], v12, s[24:27], s40 offen offset:3072
v_add_f32_e64 v47, 1.0, v207
v_fma_f32 v40, v40, v216, v40
v_mfma_f32_16x16x32_bf16 v[176:179], a[184:187], a[32:35], v[176:179]
s_waitcnt vmcnt(19) lgkmcnt(4)
v_fma_f32 v41, v41, v217, v41
v_fma_f32 v42, v42, v218, v42
v_fma_f32 v43, v43, v219, v43
v_mfma_f32_16x16x32_bf16 v[160:163], a[188:191], a[48:51], v[160:163]
ds_read_b128 a[16:19], v2 offset:45600
ds_read_b128 a[20:23], v2 offset:50208
v_fma_f32 v44, v44, v220, v44
v_mfma_f32_16x16x32_bf16 v[164:167], a[188:191], a[52:55], v[164:167]
ds_read_b128 a[24:27], v2 offset:54816
ds_read_b128 a[28:31], v2 offset:59424
v_fma_f32 v45, v45, v221, v45
v_mfma_f32_16x16x32_bf16 v[168:171], a[188:191], a[56:59], v[168:171]
buffer_load_dwordx4 a[100:103], v13, s[24:27], s40 offen offset:0
v_fma_f32 v46, v46, v222, v46
v_fma_f32 v47, v47, v223, v47
v_mfma_f32_16x16x32_bf16 v[172:175], a[188:191], a[60:63], v[172:175]
v_rcp_f32 v40, v40
v_fmac_f32_e64 v167, s11, v231
v_mfma_f32_16x16x32_bf16 v[188:191], a[192:195], a[60:63], v[188:191]
v_rcp_f32 v41, v41
v_fmac_f32 v168, s11, v232
v_mfma_f32_16x16x32_bf16 v[184:187], a[192:195], a[56:59], v[184:187]
v_rcp_f32 v42, v42
v_fmac_f32 v169, s11, v233
v_mfma_f32_16x16x32_bf16 v[180:183], a[192:195], a[52:55], v[180:183]
buffer_load_dwordx4 a[112:115], v13, s[24:27], s40 offen offset:1024
v_rcp_f32_e64 v43, v43
v_mfma_f32_16x16x32_bf16 v[176:179], a[192:195], a[48:51], v[176:179]
s_waitcnt vmcnt(19) lgkmcnt(4)
v_rcp_f32 v44, v44
v_fmac_f32_e64 v170, s11, v234
v_mfma_f32_16x16x32_bf16 v[160:163], a[196:199], a[0:3], v[160:163]
ds_read_b128 a[32:35], v2 offset:45664
ds_read_b128 a[36:39], v2 offset:50272
v_fmac_f32_e64 v175, s11, v239
v_mfma_f32_16x16x32_bf16 v[164:167], a[196:199], a[4:7], v[164:167]
buffer_load_dwordx4 a[132:135], v13, s[24:27], s40 offen offset:2048
ds_read_b128 a[40:43], v2 offset:54880
v_fmac_f32_e64 v179, s11, v243
v_mfma_f32_16x16x32_bf16 v[168:171], a[196:199], a[8:11], v[168:171]
ds_read_b128 a[44:47], v2 offset:59488
v_rcp_f32_e64 v45, v45
v_mfma_f32_16x16x32_bf16 v[172:175], a[196:199], a[12:15], v[172:175]
v_rcp_f32 v46, v46
v_fmac_f32 v180, s11, v244
v_mfma_f32_16x16x32_bf16 v[188:191], a[200:203], a[12:15], v[188:191]
v_rcp_f32_e64 v47, v47
v_fma_f32 v200, -v200, v40, v40
v_mfma_f32_16x16x32_bf16 v[184:187], a[200:203], a[8:11], v[184:187]
buffer_load_dwordx4 a[152:155], v13, s[24:27], s40 offen offset:3072
v_fma_f32 v201, -v201, v41, v41
v_fma_f32 v202, -v202, v42, v42
v_mfma_f32_16x16x32_bf16 v[180:183], a[200:203], a[4:7], v[180:183]
v_fma_f32 v203, -v203, v43, v43
v_fma_f32 v204, -v204, v44, v44
v_fma_f32 v205, -v205, v45, v45
v_mfma_f32_16x16x32_bf16 v[176:179], a[200:203], a[0:3], v[176:179]
s_waitcnt vmcnt(19) lgkmcnt(4)
v_fma_f32 v206, -v206, v46, v46
v_fma_f32 v207, -v207, v47, v47
v_cvt_pk_bf16_f32 v200, v200, v201
v_mfma_f32_16x16x32_bf16 v[160:163], a[204:207], a[16:19], v[160:163]
ds_read_b128 a[48:51], v2 offset:45728
ds_read_b128 a[52:55], v2 offset:50336
v_cvt_pk_bf16_f32 v201, v202, v203
v_mfma_f32_16x16x32_bf16 v[164:167], a[204:207], a[20:23], v[164:167]
buffer_load_dwordx4 a[104:107], v14, s[24:27], s40 offen offset:0
ds_read_b128 a[56:59], v2 offset:54944
v_cvt_pk_bf16_f32 v204, v204, v205
v_mfma_f32_16x16x32_bf16 v[168:171], a[204:207], a[24:27], v[168:171]
ds_read_b128 a[60:63], v2 offset:59552
v_cvt_pk_bf16_f32 v205, v206, v207
v_fmac_f32 v181, s11, v245
v_mfma_f32_16x16x32_bf16 v[172:175], a[204:207], a[28:31], v[172:175]
ds_write_b64 v17, v[200:201] offset:25600
v_fmac_f32_e64 v182, s11, v246
v_mfma_f32_16x16x32_bf16 v[188:191], a[208:211], a[28:31], v[188:191]
ds_write_b64 v17, v[204:205] offset:26880
v_fmac_f32_e64 v171, s11, v235
v_mfma_f32_16x16x32_bf16 v[184:187], a[208:211], a[24:27], v[184:187]
buffer_load_dwordx4 a[108:111], v14, s[24:27], s40 offen offset:1024
v_mfma_f32_16x16x32_bf16 v[180:183], a[208:211], a[20:23], v[180:183]
v_mfma_f32_16x16x32_bf16 v[176:179], a[208:211], a[16:19], v[176:179]
s_waitcnt vmcnt(19) lgkmcnt(6)
v_mfma_f32_16x16x32_bf16 v[160:163], a[212:215], a[32:35], v[160:163]
buffer_load_dwordx4 a[116:119], v14, s[24:27], s40 offen offset:2048
ds_read_b128 a[0:3], v2 offset:45792
v_fmac_f32 v188, s11, v252
v_mfma_f32_16x16x32_bf16 v[164:167], a[212:215], a[36:39], v[164:167]
ds_read_b128 a[4:7], v2 offset:50400
ds_read_b128 a[8:11], v2 offset:55008
v_fmac_f32_e64 v183, s11, v247
v_mfma_f32_16x16x32_bf16 v[168:171], a[212:215], a[40:43], v[168:171]
ds_read_b128 a[12:15], v2 offset:59616
v_fmac_f32 v184, s11, v248
v_fmac_f32 v185, s11, v249
v_mfma_f32_16x16x32_bf16 v[172:175], a[212:215], a[44:47], v[172:175]
v_mfma_f32_16x16x32_bf16 v[188:191], a[216:219], a[44:47], v[188:191]
buffer_load_dwordx4 a[120:123], v14, s[24:27], s40 offen offset:3072
v_mfma_f32_16x16x32_bf16 v[184:187], a[216:219], a[40:43], v[184:187]
v_mfma_f32_16x16x32_bf16 v[180:183], a[216:219], a[36:39], v[180:183]
v_mfma_f32_16x16x32_bf16 v[176:179], a[216:219], a[32:35], v[176:179]
s_waitcnt vmcnt(19) lgkmcnt(6)
v_mfma_f32_16x16x32_bf16 v[160:163], a[220:223], a[48:51], v[160:163]
buffer_load_dwordx4 a[124:127], v15, s[24:27], s40 offen offset:0
ds_read_b128 a[16:19], v4 offset:47872
v_fmac_f32 v189, s11, v253
v_mfma_f32_16x16x32_bf16 v[164:167], a[220:223], a[52:55], v[164:167]
ds_read_b128 a[20:23], v4 offset:52480
ds_read_b128 a[24:27], v4 offset:57088
v_fmac_f32_e64 v186, s11, v250
v_mfma_f32_16x16x32_bf16 v[168:171], a[220:223], a[56:59], v[168:171]
ds_read_b128 a[28:31], v4 offset:61696
v_fmac_f32_e64 v187, s11, v251
v_mfma_f32_16x16x32_bf16 v[172:175], a[220:223], a[60:63], v[172:175]
v_mfma_f32_16x16x32_bf16 v[188:191], a[224:227], a[60:63], v[188:191]
buffer_load_dwordx4 a[128:131], v15, s[24:27], s40 offen offset:1024
v_mfma_f32_16x16x32_bf16 v[184:187], a[224:227], a[56:59], v[184:187]
v_mfma_f32_16x16x32_bf16 v[180:183], a[224:227], a[52:55], v[180:183]
v_mfma_f32_16x16x32_bf16 v[176:179], a[224:227], a[48:51], v[176:179]
s_waitcnt vmcnt(19) lgkmcnt(4)
buffer_load_dwordx4 a[136:139], v15, s[24:27], s40 offen offset:2048
v_mfma_f32_16x16x32_bf16 v[160:163], a[228:231], a[0:3], v[160:163]
ds_read_b128 a[32:35], v4 offset:47936
ds_read_b128 a[36:39], v4 offset:52544
v_fmac_f32 v190, s11, v254
v_mfma_f32_16x16x32_bf16 v[164:167], a[228:231], a[4:7], v[164:167]
ds_read_b128 a[40:43], v4 offset:57152
ds_read_b128 a[44:47], v4 offset:61760
v_fmac_f32_e64 v191, s11, v255
v_mfma_f32_16x16x32_bf16 v[168:171], a[228:231], a[8:11], v[168:171]
v_mfma_f32_16x16x32_bf16 v[172:175], a[228:231], a[12:15], v[172:175]
buffer_load_dwordx4 a[140:143], v15, s[24:27], s40 offen offset:3072
v_mfma_f32_16x16x32_bf16 v[188:191], a[232:235], a[12:15], v[188:191]
v_mfma_f32_16x16x32_bf16 v[184:187], a[232:235], a[8:11], v[184:187]
v_mfma_f32_16x16x32_bf16 v[180:183], a[232:235], a[4:7], v[180:183]
v_mfma_f32_16x16x32_bf16 v[176:179], a[232:235], a[0:3], v[176:179]
s_waitcnt vmcnt(19) lgkmcnt(4)
s_add_u32 s40, s40, 16384
buffer_load_dwordx4 a[144:147], v12, s[24:27], s40 offen offset:0
v_mfma_f32_16x16x32_bf16 v[224:227], a[236:239], a[16:19], v[224:227]
ds_read_b128 a[48:51], v4 offset:48000
ds_read_b128 a[52:55], v4 offset:52608
v_mfma_f32_16x16x32_bf16 v[228:231], a[236:239], a[20:23], v[228:231]
ds_read_b128 a[56:59], v4 offset:57216
ds_read_b128 a[60:63], v4 offset:61824
v_mfma_f32_16x16x32_bf16 v[232:235], a[236:239], a[24:27], v[232:235]
v_min_f32 v160, s12, v160
v_min_f32 v161, s12, v161
v_min_f32 v162, s12, v162
v_mfma_f32_16x16x32_bf16 v[236:239], a[236:239], a[28:31], v[236:239]
buffer_load_dwordx4 a[148:151], v12, s[24:27], s40 offen offset:1024
v_min_f32 v163, s12, v163
v_min_f32 v164, s12, v164
v_mfma_f32_16x16x32_bf16 v[252:255], a[240:243], a[28:31], v[252:255]
v_min_f32 v165, s12, v165
v_min_f32 v166, s12, v166
v_min_f32_e64 v167, s12, v167
v_mfma_f32_16x16x32_bf16 v[248:251], a[240:243], a[24:27], v[248:251]
v_exp_f32_e64 v176, v176
v_mfma_f32_16x16x32_bf16 v[244:247], a[240:243], a[20:23], v[244:247]
buffer_load_dwordx4 a[156:159], v12, s[24:27], s40 offen offset:2048
v_exp_f32_e64 v177, v177
v_mfma_f32_16x16x32_bf16 v[240:243], a[240:243], a[16:19], v[240:243]
s_waitcnt vmcnt(20) lgkmcnt(4)
v_exp_f32 v178, v178
v_mfma_f32_16x16x32_bf16 v[224:227], a[244:247], a[32:35], v[224:227]
ds_read_b128 a[0:3], v4 offset:48064
ds_read_b128 a[4:7], v4 offset:52672
v_mfma_f32_16x16x32_bf16 v[228:231], a[244:247], a[36:39], v[228:231]
s_barrier
v_mfma_f32_16x16x32_bf16 v[232:235], a[244:247], a[40:43], v[232:235]
ds_read_b128 a[8:11], v4 offset:57280
ds_read_b128 a[12:15], v4 offset:61888
v_mfma_f32_16x16x32_bf16 v[236:239], a[244:247], a[44:47], v[236:239]
buffer_load_dwordx4 a[160:163], v12, s[24:27], s40 offen offset:3072
v_exp_f32 v179, v179
v_mfma_f32_16x16x32_bf16 v[252:255], a[248:251], a[44:47], v[252:255]
v_exp_f32_e64 v180, v180
v_mfma_f32_16x16x32_bf16 v[248:251], a[248:251], a[40:43], v[248:251]
v_exp_f32_e64 v181, v181
v_mfma_f32_16x16x32_bf16 v[244:247], a[248:251], a[36:39], v[244:247]
v_exp_f32_e64 v182, v182
v_mfma_f32_16x16x32_bf16 v[240:243], a[248:251], a[32:35], v[240:243]
s_waitcnt vmcnt(19) lgkmcnt(4)
buffer_load_dwordx4 a[164:167], v13, s[24:27], s40 offen offset:0
v_exp_f32 v183, v183
v_mfma_f32_16x16x32_bf16 v[224:227], a[252:255], a[48:51], v[224:227]
ds_read_b128 a[16:19], v5 offset:45600
ds_read_b128 a[20:23], v5 offset:50208
v_mfma_f32_16x16x32_bf16 v[228:231], a[252:255], a[52:55], v[228:231]
ds_read_b128 a[24:27], v5 offset:54816
ds_read_b128 a[28:31], v5 offset:59424
v_mfma_f32_16x16x32_bf16 v[232:235], a[252:255], a[56:59], v[232:235]
v_exp_f32_e64 v160, v160
v_mfma_f32_16x16x32_bf16 v[236:239], a[252:255], a[60:63], v[236:239]
buffer_load_dwordx4 a[168:171], v13, s[24:27], s40 offen offset:1024
v_exp_f32_e64 v161, v161
v_mfma_f32_16x16x32_bf16 v[252:255], a[72:75], a[60:63], v[252:255]
v_exp_f32_e64 v162, v162
v_mfma_f32_16x16x32_bf16 v[248:251], a[72:75], a[56:59], v[248:251]
v_exp_f32_e64 v163, v163
v_mfma_f32_16x16x32_bf16 v[244:247], a[72:75], a[52:55], v[244:247]
buffer_load_dwordx4 a[172:175], v13, s[24:27], s40 offen offset:2048
v_exp_f32_e64 v164, v164
v_mfma_f32_16x16x32_bf16 v[240:243], a[72:75], a[48:51], v[240:243]
s_waitcnt vmcnt(20) lgkmcnt(4)
v_exp_f32 v165, v165
v_mfma_f32_16x16x32_bf16 v[224:227], a[92:95], a[0:3], v[224:227]
ds_read_b128 a[32:35], v4 offset:45600
ds_read_b128 a[36:39], v4 offset:50208
v_mfma_f32_16x16x32_bf16 v[228:231], a[92:95], a[4:7], v[228:231]
ds_read_b128 a[40:43], v4 offset:54816
ds_read_b128 a[44:47], v4 offset:59424
v_mfma_f32_16x16x32_bf16 v[232:235], a[92:95], a[8:11], v[232:235]
buffer_load_dwordx4 a[176:179], v13, s[24:27], s40 offen offset:3072
v_exp_f32_e64 v166, v166
v_mfma_f32_16x16x32_bf16 v[236:239], a[92:95], a[12:15], v[236:239]
v_exp_f32 v167, v167
v_add_f32 v128, 1.0, v160
v_mfma_f32_16x16x32_bf16 v[252:255], a[88:91], a[12:15], v[252:255]
v_add_f32 v129, 1.0, v161
v_add_f32 v130, 1.0, v162
v_add_f32_e64 v131, 1.0, v163
v_mfma_f32_16x16x32_bf16 v[248:251], a[88:91], a[8:11], v[248:251]
v_add_f32 v132, 1.0, v164
v_add_f32 v133, 1.0, v165
v_add_f32_e64 v134, 1.0, v166
v_mfma_f32_16x16x32_bf16 v[244:247], a[88:91], a[4:7], v[244:247]
buffer_load_dwordx4 a[180:183], v14, s[24:27], s40 offen offset:0
v_add_f32_e64 v135, 1.0, v167
v_fma_f32 v128, v128, v176, v128
v_mfma_f32_16x16x32_bf16 v[240:243], a[88:91], a[0:3], v[240:243]
s_waitcnt vmcnt(20) lgkmcnt(4)
v_fma_f32 v129, v129, v177, v129
v_fma_f32 v130, v130, v178, v130
v_fma_f32 v131, v131, v179, v131
v_mfma_f32_16x16x32_bf16 v[224:227], a[96:99], a[16:19], v[224:227]
ds_read_b128 a[48:51], v4 offset:45664
ds_read_b128 a[52:55], v4 offset:50272
v_fma_f32 v132, v132, v180, v132
v_mfma_f32_16x16x32_bf16 v[228:231], a[96:99], a[20:23], v[228:231]
ds_read_b128 a[56:59], v4 offset:54880
ds_read_b128 a[60:63], v4 offset:59488
v_fma_f32 v133, v133, v181, v133
v_mfma_f32_16x16x32_bf16 v[232:235], a[96:99], a[24:27], v[232:235]
buffer_load_dwordx4 a[184:187], v14, s[24:27], s40 offen offset:1024
ds_read_b128 a[64:67], v96 offset:20480
v_fma_f32 v134, v134, v182, v134
v_mfma_f32_16x16x32_bf16 v[236:239], a[96:99], a[28:31], v[236:239]
ds_read_b128 a[68:71], v97 offset:20480
v_fma_f32 v135, v135, v183, v135
v_mfma_f32_16x16x32_bf16 v[252:255], a[100:103], a[28:31], v[252:255]
ds_read_b128 a[72:75], v96 offset:20544
v_rcp_f32 v128, v128
v_mfma_f32_16x16x32_bf16 v[248:251], a[100:103], a[24:27], v[248:251]
buffer_load_dwordx4 a[188:191], v14, s[24:27], s40 offen offset:2048
ds_read_b128 a[76:79], v97 offset:20544
v_mfma_f32_16x16x32_bf16 v[244:247], a[100:103], a[20:23], v[244:247]
ds_read_b128 a[80:83], v92 offset:20608
v_rcp_f32_e64 v129, v129
v_mfma_f32_16x16x32_bf16 v[240:243], a[100:103], a[16:19], v[240:243]
s_waitcnt vmcnt(20) lgkmcnt(9)
ds_read_b128 a[84:87], v93 offset:20608
v_rcp_f32 v130, v130
v_mfma_f32_16x16x32_bf16 v[224:227], a[112:115], a[32:35], v[224:227]
ds_read_b128 a[0:3], v4 offset:45728
ds_read_b128 a[4:7], v4 offset:50336
v_mfma_f32_16x16x32_bf16 v[228:231], a[112:115], a[36:39], v[228:231]
buffer_load_dwordx4 a[192:195], v14, s[24:27], s40 offen offset:3072
ds_read_b128 a[8:11], v4 offset:54944
v_mfma_f32_16x16x32_bf16 v[232:235], a[112:115], a[40:43], v[232:235]
ds_read_b128 a[12:15], v4 offset:59552
v_rcp_f32_e64 v131, v131
v_mfma_f32_16x16x32_bf16 v[236:239], a[112:115], a[44:47], v[236:239]
v_rcp_f32_e64 v132, v132
v_mfma_f32_16x16x32_bf16 v[252:255], a[132:135], a[44:47], v[252:255]
v_rcp_f32_e64 v133, v133
v_mfma_f32_16x16x32_bf16 v[248:251], a[132:135], a[40:43], v[248:251]
buffer_load_dwordx4 a[196:199], v15, s[24:27], s40 offen offset:0
v_rcp_f32_e64 v134, v134
v_mfma_f32_16x16x32_bf16 v[244:247], a[132:135], a[36:39], v[244:247]
v_rcp_f32_e64 v135, v135
v_fma_f32 v160, -v160, v128, v128
v_mfma_f32_16x16x32_bf16 v[240:243], a[132:135], a[32:35], v[240:243]
s_waitcnt vmcnt(20) lgkmcnt(10)
v_fma_f32 v161, -v161, v129, v129
v_fma_f32 v162, -v162, v130, v130
v_fma_f32 v163, -v163, v131, v131
v_mfma_f32_16x16x32_bf16 v[224:227], a[152:155], a[48:51], v[224:227]
ds_read_b128 a[16:19], v4 offset:45792
ds_read_b128 a[20:23], v4 offset:50400
v_fma_f32 v164, -v164, v132, v132
v_mfma_f32_16x16x32_bf16 v[228:231], a[152:155], a[52:55], v[228:231]
buffer_load_dwordx4 a[200:203], v15, s[24:27], s40 offen offset:1024
ds_read_b128 a[24:27], v4 offset:55008
v_fma_f32 v165, -v165, v133, v133
v_mfma_f32_16x16x32_bf16 v[232:235], a[152:155], a[56:59], v[232:235]
ds_read_b128 a[28:31], v4 offset:59616
v_fma_f32 v166, -v166, v134, v134
v_fma_f32 v167, -v167, v135, v135
v_mfma_f32_16x16x32_bf16 v[236:239], a[152:155], a[60:63], v[236:239]
v_cvt_pk_bf16_f32 v160, v160, v161
v_cvt_pk_bf16_f32 v161, v162, v163
v_cvt_pk_bf16_f32 v164, v164, v165
v_mfma_f32_16x16x32_bf16 v[252:255], a[104:107], a[60:63], v[252:255]
buffer_load_dwordx4 a[204:207], v15, s[24:27], s40 offen offset:2048
v_cvt_pk_bf16_f32 v165, v166, v167
v_mfma_f32_16x16x32_bf16 v[248:251], a[104:107], a[56:59], v[248:251]
ds_write_b64 v16, v[160:161] offset:0
v_mfma_f32_16x16x32_bf16 v[244:247], a[104:107], a[52:55], v[244:247]
ds_write_b64 v16, v[164:165] offset:1280
v_min_f32 v168, s12, v168
v_mfma_f32_16x16x32_bf16 v[240:243], a[104:107], a[48:51], v[240:243]
s_waitcnt vmcnt(20) lgkmcnt(6)
v_min_f32 v169, s12, v169
v_min_f32 v170, s12, v170
v_min_f32 v171, s12, v171
v_mfma_f32_16x16x32_bf16 v[224:227], a[108:111], a[0:3], v[224:227]
buffer_load_dwordx4 a[208:211], v15, s[24:27], s40 offen offset:3072
v_min_f32 v172, s12, v172
v_min_f32 v173, s12, v173
v_mfma_f32_16x16x32_bf16 v[228:231], a[108:111], a[4:7], v[228:231]
v_min_f32 v174, s12, v174
v_min_f32 v175, s12, v175
v_mfma_f32_16x16x32_bf16 v[232:235], a[108:111], a[8:11], v[232:235]
v_exp_f32_e64 v184, v184
v_mfma_f32_16x16x32_bf16 v[236:239], a[108:111], a[12:15], v[236:239]
v_exp_f32_e64 v185, v185
v_mfma_f32_16x16x32_bf16 v[252:255], a[116:119], a[12:15], v[252:255]
s_add_u32 s40, s40, 16384
buffer_load_dwordx4 a[212:215], v12, s[24:27], s40 offen offset:0
v_exp_f32_e64 v186, v186
v_mfma_f32_16x16x32_bf16 v[248:251], a[116:119], a[8:11], v[248:251]
v_exp_f32_e64 v187, v187
v_mfma_f32_16x16x32_bf16 v[244:247], a[116:119], a[4:7], v[244:247]
v_exp_f32_e64 v188, v188
v_mfma_f32_16x16x32_bf16 v[240:243], a[116:119], a[0:3], v[240:243]
s_waitcnt vmcnt(20) lgkmcnt(2)
v_exp_f32 v189, v189
v_mfma_f32_16x16x32_bf16 v[224:227], a[120:123], a[16:19], v[224:227]
buffer_load_dwordx4 a[216:219], v12, s[24:27], s40 offen offset:1024
v_exp_f32_e64 v190, v190
v_mfma_f32_16x16x32_bf16 v[240:243], a[124:127], a[16:19], v[240:243]
v_exp_f32_e64 v191, v191
v_mfma_f32_16x16x32_bf16 v[228:231], a[120:123], a[20:23], v[228:231]
v_exp_f32_e64 v168, v168
v_mfma_f32_16x16x32_bf16 v[244:247], a[124:127], a[20:23], v[244:247]
buffer_load_dwordx4 a[220:223], v12, s[24:27], s40 offen offset:2048
v_exp_f32_e64 v169, v169
v_mfma_f32_16x16x32_bf16 v[232:235], a[120:123], a[24:27], v[232:235]
v_exp_f32_e64 v170, v170
v_mfma_f32_16x16x32_bf16 v[248:251], a[124:127], a[24:27], v[248:251]
v_exp_f32_e64 v171, v171
v_mfma_f32_16x16x32_bf16 v[236:239], a[120:123], a[28:31], v[236:239]
v_exp_f32_e64 v172, v172
v_mfma_f32_16x16x32_bf16 v[252:255], a[124:127], a[28:31], v[252:255]
L_isl7:
s_cbranch_execz L_wret
buffer_load_dwordx4 a[224:227], v12, s[24:27], s40 offen offset:3072
v_exp_f32_e64 v173, v173
s_waitcnt vmcnt(18)
v_mfma_f32_16x16x32_bf16 v[52:55], a[148:151], a[64:67], 0
ds_read_b128 a[0:3], v96 offset:25600
ds_read_b128 a[4:7], v97 offset:25600
v_exp_f32_e64 v174, v174
v_mfma_f32_16x16x32_bf16 v[20:23], a[64:67], a[128:131], 0
ds_read_b128 a[8:11], v96 offset:25664
ds_read_b128 a[12:15], v97 offset:25664
v_exp_f32_e64 v175, v175
v_pk_add_f32 v[128:129], 1.0, v[168:169] op_sel_hi:[0,1]
v_pk_add_f32 v[130:131], 1.0, v[170:171] op_sel_hi:[0,1]
v_pk_add_f32 v[132:133], 1.0, v[172:173] op_sel_hi:[0,1]
v_pk_add_f32 v[134:135], 1.0, v[174:175] op_sel_hi:[0,1]
v_pk_fma_f32 v[128:129], v[128:129], v[184:185], v[128:129]
v_pk_fma_f32 v[130:131], v[130:131], v[186:187], v[130:131]
v_pk_fma_f32 v[132:133], v[132:133], v[188:189], v[132:133]
v_pk_fma_f32 v[134:135], v[134:135], v[190:191], v[134:135]
v_mfma_f32_16x16x32_bf16 v[24:27], a[64:67], a[136:139], 0
buffer_load_dwordx4 a[228:231], v13, s[24:27], s40 offen offset:0
ds_read_b128 a[16:19], v92 offset:25728
v_rcp_f32_e64 v128, v128
v_mfma_f32_16x16x32_bf16 v[28:31], a[64:67], a[140:143], 0
ds_read_b128 a[20:23], v93 offset:25728
v_rcp_f32_e64 v129, v129
v_mfma_f32_16x16x32_bf16 v[32:35], a[64:67], a[144:147], 0
buffer_load_dwordx4 a[232:235], v13, s[24:27], s40 offen offset:1024
v_rcp_f32_e64 v130, v130
v_mfma_f32_16x16x32_bf16 v[36:39], a[68:71], a[128:131], 0
v_rcp_f32 v131, v131
v_rcp_f32 v132, v132
v_mfma_f32_16x16x32_bf16 v[40:43], a[68:71], a[136:139], 0
v_rcp_f32 v133, v133
v_rcp_f32 v134, v134
v_rcp_f32_e64 v135, v135
v_pk_fma_f32 v[168:169], v[168:169], v[128:129], v[128:129] neg_lo:[1,0,0] neg_hi:[1,0,0]
v_pk_fma_f32 v[170:171], v[170:171], v[130:131], v[130:131] neg_lo:[1,0,0] neg_hi:[1,0,0]
v_pk_fma_f32 v[172:173], v[172:173], v[132:133], v[132:133] neg_lo:[1,0,0] neg_hi:[1,0,0]
v_pk_fma_f32 v[174:175], v[174:175], v[134:135], v[134:135] neg_lo:[1,0,0] neg_hi:[1,0,0]
v_mfma_f32_16x16x32_bf16 v[44:47], a[68:71], a[140:143], 0
v_cvt_pk_bf16_f32 v168, v168, v169
v_cvt_pk_bf16_f32 v169, v170, v171
v_cvt_pk_bf16_f32 v172, v172, v173
v_cvt_pk_bf16_f32 v173, v174, v175
v_mfma_f32_16x16x32_bf16 v[48:51], a[68:71], a[144:147], 0
ds_write_b64 v16, v[168:169] offset:5120
ds_write_b64 v16, v[172:173] offset:6400
s_waitcnt vmcnt(15)
v_mfma_f32_16x16x32_bf16 v[52:55], a[172:175], a[72:75], v[52:55]
v_min_f32 v224, s12, v224
v_min_f32 v225, s12, v225
v_min_f32 v226, s12, v226
v_min_f32_e64 v227, s12, v227
v_mfma_f32_16x16x32_bf16 v[20:23], a[72:75], a[156:159], v[20:23]
v_min_f32 v228, s12, v228
v_min_f32 v229, s12, v229
v_min_f32 v230, s12, v230
v_min_f32 v231, s12, v231
v_mfma_f32_16x16x32_bf16 v[24:27], a[72:75], a[160:163], v[24:27]
v_exp_f32 v240, v240
v_exp_f32 v241, v241
v_mfma_f32_16x16x32_bf16 v[28:31], a[72:75], a[164:167], v[28:31]
v_exp_f32 v242, v242
v_exp_f32 v243, v243
v_mfma_f32_16x16x32_bf16 v[32:35], a[72:75], a[168:171], v[32:35]
v_exp_f32 v244, v244
v_exp_f32 v245, v245
v_mfma_f32_16x16x32_bf16 v[36:39], a[76:79], a[156:159], v[36:39]
v_exp_f32 v246, v246
v_exp_f32 v247, v247
v_mfma_f32_16x16x32_bf16 v[40:43], a[76:79], a[160:163], v[40:43]
v_exp_f32 v224, v224
v_exp_f32 v225, v225
v_mfma_f32_16x16x32_bf16 v[44:47], a[76:79], a[164:167], v[44:47]
v_exp_f32 v226, v226
v_exp_f32 v227, v227
v_mfma_f32_16x16x32_bf16 v[48:51], a[76:79], a[168:171], v[48:51]
v_exp_f32 v228, v228
v_exp_f32_e64 v229, v229
s_waitcnt vmcnt(10)
v_mfma_f32_16x16x32_bf16 v[52:55], a[192:195], a[80:83], v[52:55]
v_exp_f32 v230, v230
v_exp_f32 v231, v231
v_pk_add_f32 v[128:129], 1.0, v[224:225] op_sel_hi:[0,1]
v_pk_add_f32 v[130:131], 1.0, v[226:227] op_sel_hi:[0,1]
v_pk_add_f32 v[132:133], 1.0, v[228:229] op_sel_hi:[0,1]
v_pk_add_f32 v[134:135], 1.0, v[230:231] op_sel_hi:[0,1]
v_pk_fma_f32 v[128:129], v[128:129], v[240:241], v[128:129]
v_pk_fma_f32 v[130:131], v[130:131], v[242:243], v[130:131]
v_pk_fma_f32 v[132:133], v[132:133], v[244:245], v[132:133]
v_pk_fma_f32 v[134:135], v[134:135], v[246:247], v[134:135]
v_mfma_f32_16x16x32_bf16 v[20:23], a[80:83], a[176:179], v[20:23]
v_rcp_f32 v128, v128
v_rcp_f32 v129, v129
v_mfma_f32_16x16x32_bf16 v[24:27], a[80:83], a[180:183], v[24:27]
v_rcp_f32_e64 v130, v130
v_mfma_f32_16x16x32_bf16 v[28:31], a[80:83], a[184:187], v[28:31]
v_rcp_f32 v131, v131
v_rcp_f32 v132, v132
v_mfma_f32_16x16x32_bf16 v[32:35], a[80:83], a[188:191], v[32:35]
v_rcp_f32 v133, v133
v_rcp_f32 v134, v134
v_rcp_f32_e64 v135, v135
v_pk_fma_f32 v[224:225], v[224:225], v[128:129], v[128:129] neg_lo:[1,0,0] neg_hi:[1,0,0]
v_pk_fma_f32 v[226:227], v[226:227], v[130:131], v[130:131] neg_lo:[1,0,0] neg_hi:[1,0,0]
v_pk_fma_f32 v[228:229], v[228:229], v[132:133], v[132:133] neg_lo:[1,0,0] neg_hi:[1,0,0]
v_pk_fma_f32 v[230:231], v[230:231], v[134:135], v[134:135] neg_lo:[1,0,0] neg_hi:[1,0,0]
v_mfma_f32_16x16x32_bf16 v[36:39], a[84:87], a[176:179], v[36:39]
v_cvt_pk_bf16_f32 v224, v224, v225
v_cvt_pk_bf16_f32 v225, v226, v227
v_mfma_f32_16x16x32_bf16 v[40:43], a[84:87], a[180:183], v[40:43]
v_cvt_pk_bf16_f32 v228, v228, v229
v_cvt_pk_bf16_f32 v229, v230, v231
v_mfma_f32_16x16x32_bf16 v[44:47], a[84:87], a[184:187], v[44:47]
ds_write_b64 v17, v[224:225] offset:0
v_mfma_f32_16x16x32_bf16 v[48:51], a[84:87], a[188:191], v[48:51]
ds_write_b64 v17, v[228:229] offset:1280
s_waitcnt lgkmcnt(9)
v_mfma_f32_16x16x32_bf16 v[88:91], a[148:151], a[0:3], 0
v_min_f32 v232, s12, v232
v_min_f32 v233, s12, v233
v_min_f32 v234, s12, v234
v_min_f32 v235, s12, v235
v_min_f32 v236, s12, v236
v_min_f32_e64 v237, s12, v237
v_mfma_f32_16x16x32_bf16 v[56:59], a[0:3], a[128:131], 0
v_min_f32 v238, s12, v238
v_min_f32 v239, s12, v239
v_exp_f32 v248, v248
v_exp_f32 v249, v249
s_waitcnt lgkmcnt(0)
s_barrier
v_mfma_f32_16x16x32_bf16 v[60:63], a[0:3], a[136:139], 0
ds_read_b128 a[24:27], v96 offset:0
ds_read_b128 a[32:35], v96 offset:64
v_mfma_f32_16x16x32_bf16 v[64:67], a[0:3], a[140:143], 0
ds_read_b128 a[28:31], v97 offset:0
ds_read_b128 a[36:39], v97 offset:64
v_mfma_f32_16x16x32_bf16 v[68:71], a[0:3], a[144:147], 0
v_exp_f32_e64 v250, v250
v_mfma_f32_16x16x32_bf16 v[72:75], a[4:7], a[128:131], 0
v_exp_f32_e64 v251, v251
v_mfma_f32_16x16x32_bf16 v[76:79], a[4:7], a[136:139], 0
v_exp_f32 v252, v252
s_waitcnt vmcnt(5) lgkmcnt(3)
v_mfma_f32_16x16x32_bf16 v[52:55], a[212:215], a[24:27], v[52:55]
v_exp_f32_e64 v253, v253
v_mfma_f32_16x16x32_bf16 v[20:23], a[24:27], a[196:199], v[20:23]
v_exp_f32_e64 v254, v254
v_mfma_f32_16x16x32_bf16 v[24:27], a[24:27], a[200:203], v[24:27]
v_exp_f32_e64 v255, v255
v_mfma_f32_16x16x32_bf16 v[28:31], a[24:27], a[204:207], v[28:31]
v_exp_f32_e64 v232, v232
v_mfma_f32_16x16x32_bf16 v[32:35], a[24:27], a[208:211], v[32:35]
v_exp_f32 v233, v233
s_waitcnt vmcnt(0) lgkmcnt(2)
v_mfma_f32_16x16x32_bf16 v[52:55], a[232:235], a[32:35], v[52:55]
v_exp_f32_e64 v234, v234
v_mfma_f32_16x16x32_bf16 v[20:23], a[32:35], a[216:219], v[20:23]
v_exp_f32_e64 v235, v235
v_mfma_f32_16x16x32_bf16 v[24:27], a[32:35], a[220:223], v[24:27]
v_exp_f32_e64 v236, v236
v_mfma_f32_16x16x32_bf16 v[28:31], a[32:35], a[224:227], v[28:31]
v_exp_f32_e64 v237, v237
v_mfma_f32_16x16x32_bf16 v[32:35], a[32:35], a[228:231], v[32:35]
v_exp_f32 v238, v238
v_exp_f32 v239, v239
v_pk_add_f32 v[128:129], 1.0, v[232:233] op_sel_hi:[0,1]
v_pk_add_f32 v[130:131], 1.0, v[234:235] op_sel_hi:[0,1]
v_pk_add_f32 v[132:133], 1.0, v[236:237] op_sel_hi:[0,1]
v_pk_add_f32 v[134:135], 1.0, v[238:239] op_sel_hi:[0,1]
v_pk_fma_f32 v[128:129], v[128:129], v[248:249], v[128:129]
v_pk_fma_f32 v[130:131], v[130:131], v[250:251], v[130:131]
v_pk_fma_f32 v[132:133], v[132:133], v[252:253], v[132:133]
v_pk_fma_f32 v[134:135], v[134:135], v[254:255], v[134:135]
s_waitcnt lgkmcnt(1)
v_mfma_f32_16x16x32_bf16 v[36:39], a[28:31], a[196:199], v[36:39]
v_cvt_pk_bf16_f32 v144, v52, v53
v_cvt_pk_bf16_f32 v145, v54, v55
ds_bpermute_b32 v144, v6, v144
v_mfma_f32_16x16x32_bf16 v[40:43], a[28:31], a[200:203], v[40:43]
ds_bpermute_b32 v145, v6, v145
v_cvt_pk_bf16_f32 v136, v20, v24
v_cvt_pk_bf16_f32 v138, v21, v25
v_mfma_f32_16x16x32_bf16 v[44:47], a[28:31], a[204:207], v[44:47]
v_cvt_pk_bf16_f32 v140, v22, v26
v_cvt_pk_bf16_f32 v142, v23, v27
v_cvt_pk_bf16_f32 v137, v28, v32
v_mfma_f32_16x16x32_bf16 v[48:51], a[28:31], a[208:211], v[48:51]
buffer_store_dwordx2 v[136:137], v10, s[28:31], s92 offen offset:0 nt
v_cvt_pk_bf16_f32 v139, v29, v33
buffer_store_dwordx2 v[138:139], v10, s[28:31], s92 offen offset:1152 nt
s_waitcnt lgkmcnt(2)
v_mfma_f32_16x16x32_bf16 v[36:39], a[36:39], a[216:219], v[36:39]
v_cvt_pk_bf16_f32 v141, v30, v34
buffer_store_dwordx2 v[140:141], v10, s[28:31], s92 offen offset:2304 nt
v_cvt_pk_bf16_f32 v143, v31, v35
v_mfma_f32_16x16x32_bf16 v[40:43], a[36:39], a[220:223], v[40:43]
buffer_store_dwordx2 v[142:143], v10, s[28:31], s92 offen offset:3456 nt
s_waitcnt lgkmcnt(0)
buffer_store_dwordx2 v[144:145], v11, s[28:31], s96 offen nt
v_mfma_f32_16x16x32_bf16 v[44:47], a[36:39], a[224:227], v[44:47]
v_rcp_f32 v128, v128
v_mfma_f32_16x16x32_bf16 v[48:51], a[36:39], a[228:231], v[48:51]
v_rcp_f32_e64 v129, v129
v_mfma_f32_16x16x32_bf16 v[80:83], a[4:7], a[140:143], 0
v_rcp_f32 v130, v130
v_rcp_f32 v131, v131
v_mfma_f32_16x16x32_bf16 v[84:87], a[4:7], a[144:147], 0
v_cvt_pk_bf16_f32 v146, v36, v40
v_cvt_pk_bf16_f32 v148, v37, v41
v_cvt_pk_bf16_f32 v150, v38, v42
v_cvt_pk_bf16_f32 v152, v39, v43
v_mfma_f32_16x16x32_bf16 v[88:91], a[172:175], a[8:11], v[88:91]
v_cvt_pk_bf16_f32 v147, v44, v48
buffer_store_dwordx2 v[146:147], v10, s[28:31], s93 offen offset:0 nt
v_cvt_pk_bf16_f32 v149, v45, v49
buffer_store_dwordx2 v[148:149], v10, s[28:31], s93 offen offset:1152 nt
v_mfma_f32_16x16x32_bf16 v[56:59], a[8:11], a[156:159], v[56:59]
v_cvt_pk_bf16_f32 v151, v46, v50
buffer_store_dwordx2 v[150:151], v10, s[28:31], s93 offen offset:2304 nt
v_cvt_pk_bf16_f32 v153, v47, v51
v_mfma_f32_16x16x32_bf16 v[60:63], a[8:11], a[160:163], v[60:63]
buffer_store_dwordx2 v[152:153], v10, s[28:31], s93 offen offset:3456 nt
v_rcp_f32_e64 v132, v132
v_mfma_f32_16x16x32_bf16 v[64:67], a[8:11], a[164:167], v[64:67]
v_rcp_f32 v133, v133
v_rcp_f32 v134, v134
v_rcp_f32_e64 v135, v135
v_pk_fma_f32 v[232:233], v[232:233], v[128:129], v[128:129] neg_lo:[1,0,0] neg_hi:[1,0,0]
v_pk_fma_f32 v[234:235], v[234:235], v[130:131], v[130:131] neg_lo:[1,0,0] neg_hi:[1,0,0]
v_pk_fma_f32 v[236:237], v[236:237], v[132:133], v[132:133] neg_lo:[1,0,0] neg_hi:[1,0,0]
v_pk_fma_f32 v[238:239], v[238:239], v[134:135], v[134:135] neg_lo:[1,0,0] neg_hi:[1,0,0]
v_mfma_f32_16x16x32_bf16 v[68:71], a[8:11], a[168:171], v[68:71]
v_cvt_pk_bf16_f32 v232, v232, v233
v_cvt_pk_bf16_f32 v233, v234, v235
v_mfma_f32_16x16x32_bf16 v[72:75], a[12:15], a[156:159], v[72:75]
v_cvt_pk_bf16_f32 v236, v236, v237
v_cvt_pk_bf16_f32 v237, v238, v239
v_mfma_f32_16x16x32_bf16 v[76:79], a[12:15], a[160:163], v[76:79]
ds_write_b64 v17, v[232:233] offset:5120
v_mfma_f32_16x16x32_bf16 v[80:83], a[12:15], a[164:167], v[80:83]
ds_write_b64 v17, v[236:237] offset:6400
v_mfma_f32_16x16x32_bf16 v[84:87], a[12:15], a[168:171], v[84:87]
v_mfma_f32_16x16x32_bf16 v[88:91], a[192:195], a[16:19], v[88:91]
v_mfma_f32_16x16x32_bf16 v[56:59], a[16:19], a[176:179], v[56:59]
s_waitcnt lgkmcnt(0)
s_barrier
ds_read_b128 a[40:43], v96 offset:5120
ds_read_b128 a[48:51], v96 offset:5184
v_mfma_f32_16x16x32_bf16 v[60:63], a[16:19], a[180:183], v[60:63]
ds_read_b128 a[44:47], v97 offset:5120
ds_read_b128 a[52:55], v97 offset:5184
v_mfma_f32_16x16x32_bf16 v[64:67], a[16:19], a[184:187], v[64:67]
v_mfma_f32_16x16x32_bf16 v[68:71], a[16:19], a[188:191], v[68:71]
v_mfma_f32_16x16x32_bf16 v[72:75], a[20:23], a[176:179], v[72:75]
v_mfma_f32_16x16x32_bf16 v[76:79], a[20:23], a[180:183], v[76:79]
v_mfma_f32_16x16x32_bf16 v[80:83], a[20:23], a[184:187], v[80:83]
v_mfma_f32_16x16x32_bf16 v[84:87], a[20:23], a[188:191], v[84:87]
s_waitcnt lgkmcnt(3)
v_mfma_f32_16x16x32_bf16 v[88:91], a[212:215], a[40:43], v[88:91]
v_mfma_f32_16x16x32_bf16 v[56:59], a[40:43], a[196:199], v[56:59]
v_mfma_f32_16x16x32_bf16 v[60:63], a[40:43], a[200:203], v[60:63]
v_mfma_f32_16x16x32_bf16 v[64:67], a[40:43], a[204:207], v[64:67]
v_mfma_f32_16x16x32_bf16 v[68:71], a[40:43], a[208:211], v[68:71]
s_waitcnt lgkmcnt(2)
v_mfma_f32_16x16x32_bf16 v[88:91], a[232:235], a[48:51], v[88:91]
v_mfma_f32_16x16x32_bf16 v[56:59], a[48:51], a[216:219], v[56:59]
v_mfma_f32_16x16x32_bf16 v[60:63], a[48:51], a[220:223], v[60:63]
v_mfma_f32_16x16x32_bf16 v[64:67], a[48:51], a[224:227], v[64:67]
v_mfma_f32_16x16x32_bf16 v[68:71], a[48:51], a[228:231], v[68:71]
s_waitcnt lgkmcnt(1)
v_mfma_f32_16x16x32_bf16 v[72:75], a[44:47], a[196:199], v[72:75]
s_nop 1
v_cvt_pk_bf16_f32 v168, v88, v89
v_cvt_pk_bf16_f32 v169, v90, v91
v_mfma_f32_16x16x32_bf16 v[76:79], a[44:47], a[200:203], v[76:79]
ds_bpermute_b32 v168, v6, v168
ds_bpermute_b32 v169, v6, v169
v_mfma_f32_16x16x32_bf16 v[80:83], a[44:47], a[204:207], v[80:83]
v_cvt_pk_bf16_f32 v160, v56, v60
v_cvt_pk_bf16_f32 v162, v57, v61
v_mfma_f32_16x16x32_bf16 v[84:87], a[44:47], a[208:211], v[84:87]
v_cvt_pk_bf16_f32 v164, v58, v62
v_cvt_pk_bf16_f32 v166, v59, v63
s_waitcnt lgkmcnt(2)
v_mfma_f32_16x16x32_bf16 v[72:75], a[52:55], a[216:219], v[72:75]
v_cvt_pk_bf16_f32 v161, v64, v68
buffer_store_dwordx2 v[160:161], v10, s[28:31], s94 offen offset:0
v_mfma_f32_16x16x32_bf16 v[76:79], a[52:55], a[220:223], v[76:79]
v_cvt_pk_bf16_f32 v163, v65, v69
buffer_store_dwordx2 v[162:163], v10, s[28:31], s94 offen offset:1152
v_mfma_f32_16x16x32_bf16 v[80:83], a[52:55], a[224:227], v[80:83]
v_cvt_pk_bf16_f32 v165, v66, v70
buffer_store_dwordx2 v[164:165], v10, s[28:31], s94 offen offset:2304
v_mfma_f32_16x16x32_bf16 v[84:87], a[52:55], a[228:231], v[84:87]
v_cvt_pk_bf16_f32 v167, v67, v71
buffer_store_dwordx2 v[166:167], v10, s[28:31], s94 offen offset:3456
s_waitcnt lgkmcnt(0)
buffer_store_dwordx2 v[168:169], v11, s[28:31], s97 offen
v_cvt_pk_bf16_f32 v170, v72, v76
v_cvt_pk_bf16_f32 v172, v73, v77
v_cvt_pk_bf16_f32 v174, v74, v78
v_cvt_pk_bf16_f32 v176, v75, v79
v_cvt_pk_bf16_f32 v171, v80, v84
buffer_store_dwordx2 v[170:171], v10, s[28:31], s95 offen offset:0
v_cvt_pk_bf16_f32 v173, v81, v85
buffer_store_dwordx2 v[172:173], v10, s[28:31], s95 offen offset:1152
v_cvt_pk_bf16_f32 v175, v82, v86
buffer_store_dwordx2 v[174:175], v10, s[28:31], s95 offen offset:2304
v_cvt_pk_bf16_f32 v177, v83, v87
buffer_store_dwordx2 v[176:177], v10, s[28:31], s95 offen offset:3456
L_end:
s_endpgm
L_endw:
s_waitcnt lgkmcnt(0)
s_endpgm
.section .rodata,"a"
.p2align 6
.amdhsa_kernel standalone__autoregressive_conv_wavenet__speech_kernel
  .amdhsa_next_free_vgpr 512
  .amdhsa_next_free_sgpr 102
  .amdhsa_accum_offset 256
  .amdhsa_group_segment_fixed_size 0
  .amdhsa_kernarg_size 48
  .amdhsa_user_sgpr_count 2
  .amdhsa_user_sgpr_kernarg_segment_ptr 1
  .amdhsa_system_sgpr_workgroup_id_x 1
.end_amdhsa_kernel

.text
.globl prep_kernel
.p2align 8
.type prep_kernel,@function
prep_kernel:
v_lshrrev_b32 v1, 6, v0
v_and_b32 v0, 63, v0
s_nop 0
v_readfirstlane_b32 s3, v1
s_cmp_lt_u32 s2, 162
s_cbranch_scc1 L_ptask0
s_cmp_ge_u32 s2, 194
s_cbranch_scc1 L_ptask
s_sub_u32 s40, s2, 162
s_lshr_b32 s40, s40, 3
s_mul_i32 s40, s40, 2
s_add_u32 s40, s40, s3
s_load_dwordx4 s[4:7], s[0:1], 0
s_load_dwordx4 s[8:11], s[0:1], 16
s_and_b32 s41, s2, 7
s_min_u32 s42, s41, 2
s_mul_i32 s41, s41, 31
s_add_u32 s41, s41, s42
s_mul_i32 s41, s41, 36864
s_mul_i32 s42, s40, 155648
s_add_u32 s41, s41, s42
s_sub_u32 s41, s41, 8064
v_mul_u32_u24 v1, 2432, v0
v_add_u32 v1, s41, v1
s_mov_b32 s18, 9216000
s_mov_b32 s19, 0x20000
s_mov_b32 s22, 9216000
s_mov_b32 s23, 0x20000
s_waitcnt lgkmcnt(0)
s_mov_b32 s16, s4
s_mov_b32 s17, s5
s_mov_b32 s20, s10
s_mov_b32 s21, s11
buffer_load_dword v2, v1, s[16:19], 0 offen
s_mov_b32 s35, 1
s_mov_b64 exec, 0
s_cmp_eq_u32 s40, 0
s_cbranch_scc1 L_isl0
s_cmp_eq_u32 s40, 1
s_cbranch_scc1 L_isl1
s_cmp_eq_u32 s40, 2
s_cbranch_scc1 L_isl2
s_cmp_eq_u32 s40, 3
s_cbranch_scc1 L_isl3
s_cmp_eq_u32 s40, 4
s_cbranch_scc1 L_isl4
s_cmp_eq_u32 s40, 5
s_cbranch_scc1 L_isl5
s_cmp_eq_u32 s40, 6
s_cbranch_scc1 L_isl6
s_branch L_isl7
L_phub:
s_endpgm
L_ptask:
s_sub_u32 s2, s2, 32
L_ptask0:
s_mul_i32 s2, s2, 2
s_add_u32 s2, s2, s3
s_cmp_ge_u32 s2, 421
s_cbranch_scc1 L_pend
s_load_dwordx4 s[4:7], s[0:1], 0
s_load_dwordx4 s[8:11], s[0:1], 16
s_load_dwordx4 s[12:15], s[0:1], 32
s_cmp_ge_u32 s2, 324
s_cbranch_scc1 L_prep_b
s_and_b32 s56, s2, 1
s_lshr_b32 s36, s2, 1
s_lshl_b32 s36, s36, 5
s_mul_i32 s57, s56, 0x02020000
s_add_u32 s57, s57, 0x01000c0c
s_lshl_b32 s56, s56, 4
s_lshl_b32 s36, s2, 4
s_mov_b32 s56, 0
v_and_b32 v30, 15, v0
v_lshrrev_b32 v33, 5, v0
v_bfe_u32 v51, v0, 4, 1
v_add_u32 v30, s36, v30
v_mul_u32_u24 v31, 7282, v30
v_lshrrev_b32 v31, 20, v31
v_mul_u32_u24 v32, 144, v31
v_sub_u32 v32, v30, v32
v_cmp_le_u32 vcc, 18, v31
v_mul_u32_u24 v34, 4608, v31
v_mov_b32 v35, 580608
v_cndmask_b32 v35, 0, v35, vcc
v_mul_u32_u24 v36, 2304, v33
v_lshl_add_u32 v34, v32, 2, v34
v_add3_u32 v34, v34, v35, v36
v_mul_u32_u24 v36, 1152, v51
v_add_u32 v34, v34, v36
s_mov_b32 s40, 497664
s_mov_b32 s41, 414720
s_mov_b32 s42, 331776
s_mov_b32 s43, 248832
s_mov_b32 s44, 165888
s_mov_b32 s45, 82944
s_waitcnt lgkmcnt(0)
s_mov_b32 s20, s6
s_mov_b32 s21, s7
s_mov_b32 s22, 1244160
s_mov_b32 s23, 0x20000
buffer_load_dword v26, v34, s[20:23], 0 offen offset:0
buffer_load_dword v27, v34, s[20:23], 0 offen offset:576
buffer_load_dword v18, v34, s[20:23], s44 offen offset:0
buffer_load_dword v19, v34, s[20:23], s44 offen offset:576
buffer_load_dword v10, v34, s[20:23], s42 offen offset:0
buffer_load_dword v11, v34, s[20:23], s42 offen offset:576
buffer_load_dword v2, v34, s[20:23], s40 offen offset:0
buffer_load_dword v3, v34, s[20:23], s40 offen offset:576
buffer_load_dword v22, v34, s[20:23], s45 offen offset:0
buffer_load_dword v23, v34, s[20:23], s45 offen offset:576
buffer_load_dword v14, v34, s[20:23], s43 offen offset:0
buffer_load_dword v15, v34, s[20:23], s43 offen offset:576
buffer_load_dword v6, v34, s[20:23], s41 offen offset:0
buffer_load_dword v7, v34, s[20:23], s41 offen offset:576
s_add_u32 s24, s14, 1048576
s_addc_u32 s25, s15, 0
s_mov_b32 s26, 1538048
s_mov_b32 s27, 0x20000
v_cmp_le_u32 vcc, 72, v32
v_lshrrev_b32 v39, 2, v31
v_and_b32 v40, 3, v31
v_cndmask_b32 v37, 0, 1, vcc
v_mov_b32 v44, 0xc038aa3b
v_mov_b32 v35, 0xbfb8aa3b
v_cndmask_b32 v44, v44, v35, vcc
v_mul_u32_u24 v38, 72, v37
v_sub_u32 v38, v32, v38
v_lshlrev_b32 v38, 1, v38
v_lshrrev_b32 v41, 5, v38
v_bfe_u32 v42, v38, 4, 1
v_and_b32 v43, 15, v38
v_and_b32 v49, 1, v41
v_cmp_eq_u32 s[50:51], 1, v49
v_cmp_eq_u32 s[52:53], 1, v42
v_cmp_le_u32 vcc, 128, v38
v_mul_u32_u24 v41, 374, v41
v_add_u32 v41, v41, v37
v_bfe_u32 v47, v38, 3, 1
v_mul_u32_u24 v47, 748, v47
v_and_b32 v35, 7, v38
v_lshl_add_u32 v35, v37, 3, v35
v_cndmask_b32 v43, v43, v35, vcc
s_mov_b64 s[54:55], vcc
v_lshl_add_u32 v48, v40, 4, v43
v_lshlrev_b32 v48, 4, v48
s_mov_b32 s58, 0
s_mov_b32 s59, -1
v_lshl_add_u32 v48, v51, 4, v48
v_mul_u32_u24 v45, 5, v39
v_add_u32 v45, 25, v45
v_mul_u32_u24 v35, 5, v39
v_add_u32 v35, 28, v35
v_cndmask_b32 v45, v45, v35, s[52:53]
v_add_u32 v45, v45, v41
v_mul_u32_u24 v46, 4, v39
v_add_u32 v46, 70, v46
v_mul_u32_u24 v35, 4, v39
v_add_u32 v35, 72, v35
v_cndmask_b32 v46, v46, v35, s[52:53]
v_add_u32 v46, v46, v41
v_mul_u32_u24 v36, 5, v39
v_add_u32 v36, 27, v36
v_add_u32 v36, v36, v47
v_cndmask_b32 v106, v45, v46, s[50:51]
v_cndmask_b32 v106, v106, v36, s[54:55]
v_lshl_add_u32 v106, v106, 10, v48
v_mov_b32 v114, 0xbef2b9d6
v_mov_b32 v35, 0xbed55555
v_mov_b32 v50, 0xbe638e39
v_cndmask_b32 v114, v114, v35, s[50:51]
v_cndmask_b32 v114, v114, v50, s[54:55]
v_mul_f32 v114, v114, v44
v_cndmask_b32 v107, v46, v45, s[50:51]
v_add_u32 v36, 374, v36
v_cndmask_b32 v107, v107, v36, s[54:55]
v_lshl_add_u32 v107, v107, 10, v48
v_mov_b32 v116, 0x3e555555
v_mov_b32 v35, 0x3e72b9d6
v_mov_b32 v50, 0xbe638e39
v_cndmask_b32 v116, v116, v35, s[50:51]
v_cndmask_b32 v116, v116, v50, s[54:55]
v_mul_f32 v116, v116, v44
v_cndmask_b32 v106, v106, v107, s[58:59]
v_mul_u32_u24 v45, 5, v39
v_add_u32 v45, 106, v45
v_mul_u32_u24 v35, 5, v39
v_add_u32 v35, 109, v35
v_cndmask_b32 v45, v45, v35, s[52:53]
v_add_u32 v45, v45, v41
v_mul_u32_u24 v46, 4, v39
v_add_u32 v46, 151, v46
v_mul_u32_u24 v35, 4, v39
v_add_u32 v35, 153, v35
v_cndmask_b32 v46, v46, v35, s[52:53]
v_add_u32 v46, v46, v41
v_mul_u32_u24 v36, 5, v39
v_add_u32 v36, 108, v36
v_add_u32 v36, v36, v47
v_cndmask_b32 v108, v45, v46, s[50:51]
v_cndmask_b32 v108, v108, v36, s[54:55]
v_lshl_add_u32 v108, v108, 10, v48
v_mov_b32 v118, 0x3d11a2b4
v_mov_b32 v35, 0x3ce38e39
v_mov_b32 v50, 0xbd088889
v_cndmask_b32 v118, v118, v35, s[50:51]
v_cndmask_b32 v118, v118, v50, s[54:55]
v_mul_f32 v118, v118, v44
v_cndmask_b32 v109, v46, v45, s[50:51]
v_add_u32 v36, 374, v36
v_cndmask_b32 v109, v109, v36, s[54:55]
v_lshl_add_u32 v109, v109, 10, v48
v_mov_b32 v120, 0xbc638e39
v_mov_b32 v35, 0xbc91a2b4
v_mov_b32 v50, 0xbc888889
v_cndmask_b32 v120, v120, v35, s[50:51]
v_cndmask_b32 v120, v120, v50, s[54:55]
v_mul_f32 v120, v120, v44
v_cndmask_b32 v108, v108, v109, s[58:59]
v_mul_u32_u24 v45, 3, v39
v_add_u32 v45, 188, v45
v_mul_u32_u24 v35, 2, v39
v_add_u32 v35, 277, v35
v_cndmask_b32 v45, v45, v35, s[52:53]
v_add_u32 v45, v45, v41
v_mul_u32_u24 v46, 2, v39
v_add_u32 v46, 214, v46
v_mul_u32_u24 v35, 2, v39
v_add_u32 v35, 295, v35
v_cndmask_b32 v46, v46, v35, s[52:53]
v_add_u32 v46, v46, v41
v_mul_u32_u24 v36, 3, v39
v_add_u32 v36, 187, v36
v_add_u32 v36, v36, v47
v_cndmask_b32 v110, v45, v46, s[50:51]
v_cndmask_b32 v110, v110, v36, s[54:55]
v_lshl_add_u32 v110, v110, 10, v48
v_mov_b32 v122, 0x3cb60b61
v_mov_b32 v35, 0x3c360b61
v_mov_b32 v50, 0x3c888889
v_cndmask_b32 v122, v122, v35, s[50:51]
v_cndmask_b32 v122, v122, v50, s[54:55]
v_mul_f32 v122, v122, v44
v_cndmask_b32 v111, v46, v45, s[50:51]
v_add_u32 v36, 374, v36
v_cndmask_b32 v111, v111, v36, s[54:55]
v_lshl_add_u32 v111, v111, 10, v48
v_mov_b32 v124, 0xbbb60b61
v_mov_b32 v35, 0xbc360b61
v_mov_b32 v50, 0x3c888889
v_cndmask_b32 v124, v124, v35, s[50:51]
v_cndmask_b32 v124, v124, v50, s[54:55]
v_mul_f32 v124, v124, v44
v_cndmask_b32 v110, v110, v111, s[58:59]
v_mul_u32_u24 v45, 3, v39
v_add_u32 v45, 233, v45
v_mul_u32_u24 v35, 2, v39
v_add_u32 v35, 313, v35
v_cndmask_b32 v45, v45, v35, s[52:53]
v_add_u32 v45, v45, v41
v_mul_u32_u24 v46, 2, v39
v_add_u32 v46, 259, v46
v_mul_u32_u24 v35, 2, v39
v_add_u32 v35, 331, v35
v_cndmask_b32 v46, v46, v35, s[52:53]
v_add_u32 v46, v46, v41
v_mul_u32_u24 v36, 3, v39
v_add_u32 v36, 232, v36
v_add_u32 v36, v36, v47
v_cndmask_b32 v112, v45, v46, s[50:51]
v_cndmask_b32 v112, v112, v36, s[54:55]
v_lshl_add_u32 v112, v112, 10, v48
v_mov_b32 v126, 0xbf800000
v_mov_b32 v35, 0xbf800000
v_mov_b32 v50, 0xbf800000
v_cndmask_b32 v126, v126, v35, s[50:51]
v_cndmask_b32 v126, v126, v50, s[54:55]
v_mul_f32 v126, v126, v44
v_cndmask_b32 v113, v46, v45, s[50:51]
v_add_u32 v36, 374, v36
v_cndmask_b32 v113, v113, v36, s[54:55]
v_lshl_add_u32 v113, v113, 10, v48
v_mov_b32 v128, 0x3f800000
v_mov_b32 v35, 0x3f800000
v_mov_b32 v50, 0x3f800000
v_cndmask_b32 v128, v128, v35, s[50:51]
v_cndmask_b32 v128, v128, v50, s[54:55]
v_mul_f32 v128, v128, v44
v_cndmask_b32 v112, v112, v113, s[58:59]
s_mov_b32 s39, 0xffff0000
s_waitcnt vmcnt(12)
v_lshlrev_b32 v54, 16, v26
v_lshlrev_b32 v55, 16, v27
v_and_b32 v56, s39, v26
v_and_b32 v57, s39, v27
s_waitcnt vmcnt(10)
v_lshlrev_b32 v46, 16, v18
v_lshlrev_b32 v47, 16, v19
v_and_b32 v48, s39, v18
v_and_b32 v49, s39, v19
s_waitcnt vmcnt(8)
v_lshlrev_b32 v38, 16, v10
v_lshlrev_b32 v39, 16, v11
v_and_b32 v40, s39, v10
v_and_b32 v41, s39, v11
s_waitcnt vmcnt(6)
v_lshlrev_b32 v30, 16, v2
v_lshlrev_b32 v31, 16, v3
v_and_b32 v32, s39, v2
v_and_b32 v33, s39, v3
v_pk_add_f32 v[58:59], v[54:55], v[46:47]
v_pk_add_f32 v[60:61], v[56:57], v[48:49]
v_pk_fma_f32 v[66:67], v[54:55], 4.0, v[46:47] op_sel_hi:[1,0,1]
v_pk_fma_f32 v[68:69], v[56:57], 4.0, v[48:49] op_sel_hi:[1,0,1]
v_pk_fma_f32 v[74:75], v[30:31], 4.0, v[38:39] op_sel_hi:[1,0,1]
v_pk_fma_f32 v[76:77], v[32:33], 4.0, v[40:41] op_sel_hi:[1,0,1]
v_pk_add_f32 v[58:59], v[58:59], v[38:39]
v_pk_add_f32 v[60:61], v[60:61], v[40:41]
v_pk_fma_f32 v[66:67], v[66:67], 4.0, v[38:39] op_sel_hi:[1,0,1]
v_pk_fma_f32 v[68:69], v[68:69], 4.0, v[40:41] op_sel_hi:[1,0,1]
v_pk_fma_f32 v[74:75], v[74:75], 4.0, v[46:47] op_sel_hi:[1,0,1]
v_pk_fma_f32 v[76:77], v[76:77], 4.0, v[48:49] op_sel_hi:[1,0,1]
v_pk_add_f32 v[58:59], v[58:59], v[30:31]
v_pk_add_f32 v[60:61], v[60:61], v[32:33]
v_pk_fma_f32 v[66:67], v[66:67], 4.0, v[30:31] op_sel_hi:[1,0,1]
v_pk_fma_f32 v[68:69], v[68:69], 4.0, v[32:33] op_sel_hi:[1,0,1]
v_pk_fma_f32 v[74:75], v[74:75], 4.0, v[54:55] op_sel_hi:[1,0,1]
v_pk_fma_f32 v[76:77], v[76:77], 4.0, v[56:57] op_sel_hi:[1,0,1]
v_pk_mul_f32 v[82:83], v[30:31], v[126:127] op_sel_hi:[1,0]
v_pk_mul_f32 v[84:85], v[32:33], v[126:127] op_sel_hi:[1,0]
v_pk_mul_f32 v[86:87], v[54:55], v[128:129] op_sel_hi:[1,0]
v_pk_mul_f32 v[88:89], v[56:57], v[128:129] op_sel_hi:[1,0]
s_waitcnt vmcnt(4)
v_lshlrev_b32 v50, 16, v22
v_lshlrev_b32 v51, 16, v23
v_and_b32 v52, s39, v22
v_and_b32 v53, s39, v23
s_waitcnt vmcnt(2)
v_lshlrev_b32 v42, 16, v14
v_lshlrev_b32 v43, 16, v15
v_and_b32 v44, s39, v14
v_and_b32 v45, s39, v15
s_waitcnt vmcnt(0)
v_lshlrev_b32 v34, 16, v6
v_lshlrev_b32 v35, 16, v7
v_and_b32 v36, s39, v6
v_and_b32 v37, s39, v7
v_cvt_pk_bf16_f32 v102, v82, v83
v_cvt_pk_bf16_f32 v103, v84, v85
v_cvt_pk_bf16_f32 v104, v86, v87
v_cvt_pk_bf16_f32 v105, v88, v89
s_nop 1
v_permlane16_swap_b32 v102, v103
v_permlane16_swap_b32 v104, v105
s_nop 1
v_permlane32_swap_b32 v102, v104
v_permlane32_swap_b32 v103, v105
buffer_store_dwordx4 v[102:105], v112, s[24:27], s56 offen offset:0
v_pk_add_f32 v[62:63], v[50:51], v[42:43]
v_pk_add_f32 v[64:65], v[52:53], v[44:45]
v_pk_fma_f32 v[70:71], v[50:51], 4.0, v[42:43] op_sel_hi:[1,0,1]
v_pk_fma_f32 v[72:73], v[52:53], 4.0, v[44:45] op_sel_hi:[1,0,1]
v_pk_fma_f32 v[78:79], v[34:35], 4.0, v[42:43] op_sel_hi:[1,0,1]
v_pk_fma_f32 v[80:81], v[36:37], 4.0, v[44:45] op_sel_hi:[1,0,1]
v_pk_add_f32 v[62:63], v[62:63], v[34:35]
v_pk_add_f32 v[64:65], v[64:65], v[36:37]
v_pk_fma_f32 v[70:71], v[70:71], 4.0, v[34:35] op_sel_hi:[1,0,1]
v_pk_fma_f32 v[72:73], v[72:73], 4.0, v[36:37] op_sel_hi:[1,0,1]
v_pk_fma_f32 v[78:79], v[78:79], 4.0, v[50:51] op_sel_hi:[1,0,1]
v_pk_fma_f32 v[80:81], v[80:81], 4.0, v[52:53] op_sel_hi:[1,0,1]
v_pk_fma_f32 v[82:83], v[62:63], 1.0, v[58:59] op_sel_hi:[1,0,1]
v_pk_fma_f32 v[84:85], v[64:65], 1.0, v[60:61] op_sel_hi:[1,0,1]
v_pk_fma_f32 v[86:87], v[62:63], 1.0, v[58:59] op_sel_hi:[1,0,1] neg_lo:[1,0,0] neg_hi:[1,0,0]
v_pk_fma_f32 v[88:89], v[64:65], 1.0, v[60:61] op_sel_hi:[1,0,1] neg_lo:[1,0,0] neg_hi:[1,0,0]
v_pk_mul_f32 v[82:83], v[82:83], v[114:115] op_sel_hi:[1,0]
v_pk_mul_f32 v[84:85], v[84:85], v[114:115] op_sel_hi:[1,0]
v_pk_mul_f32 v[86:87], v[86:87], v[116:117] op_sel_hi:[1,0]
v_pk_mul_f32 v[88:89], v[88:89], v[116:117] op_sel_hi:[1,0]
v_cvt_pk_bf16_f32 v90, v82, v83
v_cvt_pk_bf16_f32 v91, v84, v85
v_cvt_pk_bf16_f32 v92, v86, v87
v_cvt_pk_bf16_f32 v93, v88, v89
s_nop 1
v_permlane16_swap_b32 v90, v91
v_permlane16_swap_b32 v92, v93
s_nop 1
v_permlane32_swap_b32 v90, v92
v_permlane32_swap_b32 v91, v93
buffer_store_dwordx4 v[90:93], v106, s[24:27], s56 offen offset:0
v_pk_fma_f32 v[82:83], v[70:71], 2.0, v[66:67] op_sel_hi:[1,0,1]
v_pk_fma_f32 v[84:85], v[72:73], 2.0, v[68:69] op_sel_hi:[1,0,1]
v_pk_fma_f32 v[86:87], v[70:71], 2.0, v[66:67] op_sel_hi:[1,0,1] neg_lo:[1,0,0] neg_hi:[1,0,0]
v_pk_fma_f32 v[88:89], v[72:73], 2.0, v[68:69] op_sel_hi:[1,0,1] neg_lo:[1,0,0] neg_hi:[1,0,0]
v_pk_mul_f32 v[82:83], v[82:83], v[118:119] op_sel_hi:[1,0]
v_pk_mul_f32 v[84:85], v[84:85], v[118:119] op_sel_hi:[1,0]
v_pk_mul_f32 v[86:87], v[86:87], v[120:121] op_sel_hi:[1,0]
v_pk_mul_f32 v[88:89], v[88:89], v[120:121] op_sel_hi:[1,0]
v_cvt_pk_bf16_f32 v94, v82, v83
v_cvt_pk_bf16_f32 v95, v84, v85
v_cvt_pk_bf16_f32 v96, v86, v87
v_cvt_pk_bf16_f32 v97, v88, v89
s_nop 1
v_permlane16_swap_b32 v94, v95
v_permlane16_swap_b32 v96, v97
s_nop 1
v_permlane32_swap_b32 v94, v96
v_permlane32_swap_b32 v95, v97
buffer_store_dwordx4 v[94:97], v108, s[24:27], s56 offen offset:0
v_pk_fma_f32 v[82:83], v[78:79], 2.0, v[74:75] op_sel_hi:[1,0,1]
v_pk_fma_f32 v[84:85], v[80:81], 2.0, v[76:77] op_sel_hi:[1,0,1]
v_pk_fma_f32 v[86:87], v[78:79], 2.0, v[74:75] op_sel_hi:[1,0,1] neg_lo:[1,0,0] neg_hi:[1,0,0]
v_pk_fma_f32 v[88:89], v[80:81], 2.0, v[76:77] op_sel_hi:[1,0,1] neg_lo:[1,0,0] neg_hi:[1,0,0]
v_pk_mul_f32 v[82:83], v[82:83], v[122:123] op_sel_hi:[1,0]
v_pk_mul_f32 v[84:85], v[84:85], v[122:123] op_sel_hi:[1,0]
v_pk_mul_f32 v[86:87], v[86:87], v[124:125] op_sel_hi:[1,0]
v_pk_mul_f32 v[88:89], v[88:89], v[124:125] op_sel_hi:[1,0]
v_cvt_pk_bf16_f32 v98, v82, v83
v_cvt_pk_bf16_f32 v99, v84, v85
v_cvt_pk_bf16_f32 v100, v86, v87
v_cvt_pk_bf16_f32 v101, v88, v89
s_nop 1
v_permlane16_swap_b32 v98, v99
v_permlane16_swap_b32 v100, v101
s_nop 1
v_permlane32_swap_b32 v98, v100
v_permlane32_swap_b32 v99, v101
buffer_store_dwordx4 v[98:101], v110, s[24:27], s56 offen offset:0
s_endpgm
L_prep_b:
s_cmp_lt_u32 s2, 374
s_cbranch_scc1 L_prep_wo
s_cmp_ge_u32 s2, 415
s_cbranch_scc1 L_prep_co
s_sub_u32 s36, s2, 374
s_lshl_b32 s36, s36, 6
v_add_u32 v108, s36, v0
v_mul_u32_u24 v109, 7282, v108
v_lshrrev_b32 v109, 20, v109
v_mul_u32_u24 v110, 144, v109
v_sub_u32 v110, v108, v110
v_mul_u32_u24 v111, 4608, v109
v_lshl_add_u32 v111, v110, 2, v111
s_mov_b32 s40, 580608
s_waitcnt lgkmcnt(0)
s_mov_b32 s20, s6
s_mov_b32 s21, s7
s_mov_b32 s22, 1244160
s_mov_b32 s23, 0x20000
buffer_load_dword v2, v111, s[20:23], s40 offen offset:0
buffer_load_dword v3, v111, s[20:23], s40 offen offset:576
buffer_load_dword v4, v111, s[20:23], s40 offen offset:1152
buffer_load_dword v5, v111, s[20:23], s40 offen offset:1728
buffer_load_dword v6, v111, s[20:23], s40 offen offset:2304
buffer_load_dword v7, v111, s[20:23], s40 offen offset:2880
buffer_load_dword v8, v111, s[20:23], s40 offen offset:3456
buffer_load_dword v9, v111, s[20:23], s40 offen offset:4032
s_add_u32 s24, s14, 1048576
s_addc_u32 s25, s15, 0
s_mov_b32 s26, 1538048
s_mov_b32 s27, 0x20000
v_cmp_le_u32 vcc, 72, v110
v_mov_b32 v120, 0x7f000000
s_nop 0
v_cndmask_b32 v112, 0, 1, vcc
v_mov_b32 v123, 0xc038aa3b
v_mov_b32 v118, 0xbfb8aa3b
v_cndmask_b32 v123, v123, v118, vcc
v_mul_u32_u24 v113, 72, v112
v_sub_u32 v113, v110, v113
v_lshlrev_b32 v113, 1, v113
v_lshrrev_b32 v114, 5, v113
v_bfe_u32 v115, v113, 4, 1
v_and_b32 v116, 15, v113
v_mad_u32_u24 v117, v115, 3, v112
v_and_b32 v118, 1, v114
v_cmp_eq_u32 vcc, 1, v118
v_mov_b32 v124, 0x40088889
v_mov_b32 v118, 0x3f888889
v_cndmask_b32 v124, v124, v118, vcc
v_cmp_le_u32 vcc, 128, v113
v_mov_b32 v118, 0x40400000
s_nop 0
v_cndmask_b32 v124, v124, v118, vcc
v_mul_f32 v124, v124, v123
v_mul_f32 v125, 0x3fc00000, v123
v_bfe_u32 v118, v113, 3, 1
v_lshlrev_b32 v118, 1, v118
v_cndmask_b32 v114, v114, v118, vcc
v_cndmask_b32 v117, v117, 2, vcc
v_and_b32 v118, 7, v113
v_lshl_add_u32 v118, v112, 3, v118
v_cndmask_b32 v116, v116, v118, vcc
v_mov_b32 v118, 382976
v_cndmask_b32 v120, v120, v118, vcc
v_mul_u32_u24 v114, 374, v114
v_add_u32 v114, v114, v117
v_lshlrev_b32 v114, 10, v114
v_lshl_add_u32 v119, v116, 4, v114
v_cmp_le_u32 vcc, 18, v109
v_mov_b32 v118, 0x7f000000
s_nop 0
v_cndmask_b32 v119, v119, v118, vcc
v_cndmask_b32 v120, v120, 0, vcc
v_lshrrev_b32 v122, 2, v109
v_mul_u32_u24 v122, 5120, v122
v_and_b32 v121, 3, v109
v_lshl_add_u32 v122, v121, 8, v122
v_add_u32 v119, v119, v122
v_add_u32 v120, v119, v120
s_mov_b32 s39, 0xffff0000
s_waitcnt vmcnt(0)
v_lshlrev_b32 v30, 16, v2
v_lshlrev_b32 v31, 16, v3
v_lshlrev_b32 v32, 16, v4
v_lshlrev_b32 v33, 16, v5
v_lshlrev_b32 v34, 16, v6
v_lshlrev_b32 v35, 16, v7
v_lshlrev_b32 v36, 16, v8
v_lshlrev_b32 v37, 16, v9
v_mul_f32 v38, v124, v30
v_mul_f32 v39, v124, v31
v_mul_f32 v40, v124, v32
v_mul_f32 v41, v124, v33
v_mul_f32 v42, v124, v34
v_mul_f32 v43, v124, v35
v_mul_f32 v44, v124, v36
v_mul_f32 v45, v124, v37
v_cvt_pk_bf16_f32 v80, v38, v39
v_cvt_pk_bf16_f32 v81, v40, v41
v_cvt_pk_bf16_f32 v82, v42, v43
v_cvt_pk_bf16_f32 v83, v44, v45
buffer_store_dwordx4 v[80:83], v119, s[24:27], 0 offen offset:0
v_mul_f32 v46, v125, v30
v_mul_f32 v47, v125, v31
v_mul_f32 v48, v125, v32
v_mul_f32 v49, v125, v33
v_mul_f32 v50, v125, v34
v_mul_f32 v51, v125, v35
v_mul_f32 v52, v125, v36
v_mul_f32 v53, v125, v37
v_cvt_pk_bf16_f32 v84, v46, v47
v_cvt_pk_bf16_f32 v85, v48, v49
v_cvt_pk_bf16_f32 v86, v50, v51
v_cvt_pk_bf16_f32 v87, v52, v53
buffer_store_dwordx4 v[84:87], v120, s[24:27], 0 offen offset:0
v_and_b32 v54, s39, v2
v_and_b32 v55, s39, v3
v_and_b32 v56, s39, v4
v_and_b32 v57, s39, v5
v_and_b32 v58, s39, v6
v_and_b32 v59, s39, v7
v_and_b32 v60, s39, v8
v_and_b32 v61, s39, v9
v_mul_f32 v62, v124, v54
v_mul_f32 v63, v124, v55
v_mul_f32 v64, v124, v56
v_mul_f32 v65, v124, v57
v_mul_f32 v66, v124, v58
v_mul_f32 v67, v124, v59
v_mul_f32 v68, v124, v60
v_mul_f32 v69, v124, v61
v_cvt_pk_bf16_f32 v88, v62, v63
v_cvt_pk_bf16_f32 v89, v64, v65
v_cvt_pk_bf16_f32 v90, v66, v67
v_cvt_pk_bf16_f32 v91, v68, v69
buffer_store_dwordx4 v[88:91], v119, s[24:27], 0 offen offset:16
v_mul_f32 v70, v125, v54
v_mul_f32 v71, v125, v55
v_mul_f32 v72, v125, v56
v_mul_f32 v73, v125, v57
v_mul_f32 v74, v125, v58
v_mul_f32 v75, v125, v59
v_mul_f32 v76, v125, v60
v_mul_f32 v77, v125, v61
v_cvt_pk_bf16_f32 v92, v70, v71
v_cvt_pk_bf16_f32 v93, v72, v73
v_cvt_pk_bf16_f32 v94, v74, v75
v_cvt_pk_bf16_f32 v95, v76, v77
buffer_store_dwordx4 v[92:95], v120, s[24:27], 0 offen offset:16
s_endpgm
L_prep_co:
s_sub_u32 s40, s2, 415
s_cmp_ge_u32 s40, 3
s_cselect_b32 s41, 4, 0
s_cselect_b32 s42, 3, 0
s_sub_u32 s42, s40, s42
s_lshl_b32 s42, s42, 2
v_bfe_u32 v2, v0, 2, 2
v_add_u32 v2, s41, v2
v_and_b32 v3, 3, v0
v_add_u32 v3, s42, v3
v_lshrrev_b32 v4, 5, v0
v_lshlrev_b32 v4, 3, v4
v_bfe_u32 v5, v0, 4, 1
v_lshl_add_u32 v4, v5, 1, v4
v_sub_u32 v4, v4, v3
s_lshl_b32 s40, s40, 10
s_add_u32 s40, s40, 1531904
v_lshlrev_b32 v6, 4, v0
v_add_u32 v6, s40, v6
v_mov_b32 v8, 0x3f800000
v_mov_b32 v9, 0xc0883f80
v_mov_b32 v10, 0x3f80c088
v_mov_b32 v11, 0x3f80
v_cmp_eq_u32 vcc, 1, v2
v_mov_b32 v12, 0xbf800000
v_mov_b32 v13, 0x40883f80
v_mov_b32 v14, 0xbf80c088
v_mov_b32 v15, 0x3f80
v_cndmask_b32 v8, v8, v12, vcc
v_cndmask_b32 v9, v9, v13, vcc
v_cndmask_b32 v10, v10, v14, vcc
v_cndmask_b32 v11, v11, v15, vcc
v_cmp_eq_u32 vcc, 2, v2
v_mov_b32 v12, 0x3f000000
v_mov_b32 v13, 0xc0203e80
v_mov_b32 v14, 0x4000bfa0
v_mov_b32 v15, 0x3f80
v_cndmask_b32 v8, v8, v12, vcc
v_cndmask_b32 v9, v9, v13, vcc
v_cndmask_b32 v10, v10, v14, vcc
v_cndmask_b32 v11, v11, v15, vcc
v_cmp_eq_u32 vcc, 3, v2
v_mov_b32 v12, 0xbf000000
v_mov_b32 v13, 0x40203e80
v_mov_b32 v14, 0xc000bfa0
v_mov_b32 v15, 0x3f80
v_cndmask_b32 v8, v8, v12, vcc
v_cndmask_b32 v9, v9, v13, vcc
v_cndmask_b32 v10, v10, v14, vcc
v_cndmask_b32 v11, v11, v15, vcc
v_cmp_eq_u32 vcc, 4, v2
v_mov_b32 v12, 0x40000000
v_mov_b32 v13, 0xc0204080
v_mov_b32 v14, 0x3f00c0a0
v_mov_b32 v15, 0x3f80
v_cndmask_b32 v8, v8, v12, vcc
v_cndmask_b32 v9, v9, v13, vcc
v_cndmask_b32 v10, v10, v14, vcc
v_cndmask_b32 v11, v11, v15, vcc
v_cmp_eq_u32 vcc, 5, v2
v_mov_b32 v12, 0xc0000000
v_mov_b32 v13, 0x40204080
v_mov_b32 v14, 0xbf00c0a0
v_mov_b32 v15, 0x3f80
v_cndmask_b32 v8, v8, v12, vcc
v_cndmask_b32 v9, v9, v13, vcc
v_cndmask_b32 v10, v10, v14, vcc
v_cndmask_b32 v11, v11, v15, vcc
v_cmp_eq_u32 vcc, 6, v2
v_mov_b32 v12, 0xbf80
v_mov_b32 v13, 0x40a8
v_mov_b32 v14, 0xc0a8
v_mov_b32 v15, 0x3f80
v_cndmask_b32 v8, v8, v12, vcc
v_cndmask_b32 v9, v9, v13, vcc
v_cndmask_b32 v10, v10, v14, vcc
v_cndmask_b32 v11, v11, v15, vcc
v_cmp_eq_u32 vcc, 7, v2
v_mov_b32 v12, 0xbf800000
v_mov_b32 v13, 0x40a80000
v_mov_b32 v14, 0xc0a80000
v_mov_b32 v15, 0x3f800000
v_cndmask_b32 v8, v8, v12, vcc
v_cndmask_b32 v9, v9, v13, vcc
v_cndmask_b32 v10, v10, v14, vcc
v_cndmask_b32 v11, v11, v15, vcc
v_add_u32 v5, 0, v4
v_mov_b32 v12, 0
v_cmp_eq_u32 vcc, 0, v5
s_nop 1
v_cndmask_b32 v12, v12, v8, vcc
v_cmp_eq_u32 vcc, 1, v5
s_nop 1
v_cndmask_b32 v12, v12, v9, vcc
v_cmp_eq_u32 vcc, 2, v5
s_nop 1
v_cndmask_b32 v12, v12, v10, vcc
v_cmp_eq_u32 vcc, 3, v5
s_nop 1
v_cndmask_b32 v12, v12, v11, vcc
v_add_u32 v5, 1, v4
v_mov_b32 v13, 0
v_cmp_eq_u32 vcc, 0, v5
s_nop 1
v_cndmask_b32 v13, v13, v8, vcc
v_cmp_eq_u32 vcc, 1, v5
s_nop 1
v_cndmask_b32 v13, v13, v9, vcc
v_cmp_eq_u32 vcc, 2, v5
s_nop 1
v_cndmask_b32 v13, v13, v10, vcc
v_cmp_eq_u32 vcc, 3, v5
s_nop 1
v_cndmask_b32 v13, v13, v11, vcc
v_add_u32 v5, 4, v4
v_mov_b32 v14, 0
v_cmp_eq_u32 vcc, 0, v5
s_nop 1
v_cndmask_b32 v14, v14, v8, vcc
v_cmp_eq_u32 vcc, 1, v5
s_nop 1
v_cndmask_b32 v14, v14, v9, vcc
v_cmp_eq_u32 vcc, 2, v5
s_nop 1
v_cndmask_b32 v14, v14, v10, vcc
v_cmp_eq_u32 vcc, 3, v5
s_nop 1
v_cndmask_b32 v14, v14, v11, vcc
v_add_u32 v5, 5, v4
v_mov_b32 v15, 0
v_cmp_eq_u32 vcc, 0, v5
s_nop 1
v_cndmask_b32 v15, v15, v8, vcc
v_cmp_eq_u32 vcc, 1, v5
s_nop 1
v_cndmask_b32 v15, v15, v9, vcc
v_cmp_eq_u32 vcc, 2, v5
s_nop 1
v_cndmask_b32 v15, v15, v10, vcc
v_cmp_eq_u32 vcc, 3, v5
s_nop 1
v_cndmask_b32 v15, v15, v11, vcc
s_waitcnt lgkmcnt(0)
s_add_u32 s24, s14, 1048576
s_addc_u32 s25, s15, 0
s_mov_b32 s26, 1538048
s_mov_b32 s27, 0x20000
buffer_store_dwordx4 v[12:15], v6, s[24:27], 0 offen offset:0
s_endpgm
L_prep_wo:
s_sub_u32 s36, s2, 324
s_lshl_b32 s36, s36, 6
v_add_u32 v108, s36, v0
v_mul_u32_u24 v109, 52429, v108
v_lshrrev_b32 v109, 21, v109
v_mul_u32_u24 v112, 40, v109
v_sub_u32 v112, v108, v112
v_and_b32 v111, 3, v109
v_lshrrev_b32 v109, 2, v109
v_cmp_gt_u32 s[50:51], 32, v112
v_and_b32 v110, 1, v111
s_nop 0
v_cndmask_b32 v110, 1, v110, s[50:51]
v_lshlrev_b32 v113, 1, v112
v_lshl_add_u32 v113, v110, 6, v113
v_and_b32 v118, 1, v112
v_lshlrev_b32 v118, 1, v118
v_cndmask_b32 v114, 4, v118, s[50:51]
v_lshrrev_b32 v118, 1, v112
v_and_b32 v119, 7, v112
v_lshlrev_b32 v119, 1, v119
v_cndmask_b32 v115, v119, v118, s[50:51]
v_cmp_le_u32 vcc, 12, v109
v_subrev_u32 v118, 12, v109
s_nop 0
v_cndmask_b32 v116, v109, v118, vcc
v_cndmask_b32 v119, 0, 16, vcc
v_lshrrev_b32 v117, 1, v116
v_lshl_add_u32 v117, v117, 5, v119
v_and_b32 v118, 1, v116
v_lshl_add_u32 v117, v118, 3, v117
v_mul_u32_u24 v117, 288, v117
v_lshl_add_u32 v117, v113, 1, v117
v_lshrrev_b32 v118, 1, v109
v_cmp_eq_u32 vcc, 5, v118
v_mov_b32 v119, 0x7fff0000
s_nop 0
v_cndmask_b32 v117, v117, v119, vcc
s_waitcnt lgkmcnt(0)
s_mov_b32 s20, s8
s_mov_b32 s21, s9
s_mov_b32 s22, 41472
s_mov_b32 s23, 0x20000
buffer_load_dword v2, v117, s[20:23], 0 offen offset:0
buffer_load_dword v3, v117, s[20:23], 0 offen offset:288
buffer_load_dword v4, v117, s[20:23], 0 offen offset:576
buffer_load_dword v5, v117, s[20:23], 0 offen offset:864
buffer_load_dword v6, v117, s[20:23], 0 offen offset:1152
buffer_load_dword v7, v117, s[20:23], 0 offen offset:1440
buffer_load_dword v8, v117, s[20:23], 0 offen offset:1728
buffer_load_dword v9, v117, s[20:23], 0 offen offset:2016
s_add_u32 s24, s14, 1048576
s_addc_u32 s25, s15, 0
s_mov_b32 s26, 1538048
s_mov_b32 s27, 0x20000
v_lshrrev_b32 v118, 2, v109
v_mad_u32_u24 v118, v118, 5, v114
v_mul_u32_u24 v111, 374, v111
v_add_u32 v118, v118, v111
v_add_u32 v118, 349, v118
v_and_b32 v119, 3, v109
v_lshl_add_u32 v119, v119, 4, v115
v_lshlrev_b32 v119, 4, v119
v_lshl_add_u32 v120, v118, 10, v119
v_mov_b32 v118, 1024
v_cndmask_b32 v118, 16, v118, s[50:51]
v_add_u32 v110, v118, v120
s_mov_b32 s36, 0x05040100
s_mov_b32 s37, 0x07060302
s_waitcnt vmcnt(0)
v_perm_b32 v84, v3, v2, s36
v_perm_b32 v85, v5, v4, s36
v_perm_b32 v86, v7, v6, s36
v_perm_b32 v87, v9, v8, s36
buffer_store_dwordx4 v[84:87], v120, s[24:27], 0 offen offset:0
v_perm_b32 v88, v3, v2, s37
v_perm_b32 v89, v5, v4, s37
v_perm_b32 v90, v7, v6, s37
v_perm_b32 v91, v9, v8, s37
buffer_store_dwordx4 v[88:91], v110, s[24:27], 0 offen offset:0
s_endpgm
L_pend:
s_endpgm
.section .rodata,"a"
.p2align 6
.amdhsa_kernel prep_kernel
  .amdhsa_next_free_vgpr 136
  .amdhsa_next_free_sgpr 102
  .amdhsa_accum_offset 136
  .amdhsa_group_segment_fixed_size 0
  .amdhsa_kernarg_size 48
  .amdhsa_user_sgpr_count 2
  .amdhsa_user_sgpr_kernarg_segment_ptr 1
  .amdhsa_system_sgpr_workgroup_id_x 1
.end_amdhsa_kernel
```
